```python
import torch

def _softmax(x, axis=-1):
    return torch.softmax(x, dim=axis)
def _gelu(x):
    return torch.nn.functional.gelu(x, approximate="tanh")
def _silu(x):
    return torch.nn.functional.silu(x)
def _sigmoid(x):
    return torch.sigmoid(x)
def _layernorm(x, axis=-1, eps=1e-5):
    m = x.mean(dim=axis, keepdim=True)
    v = x.var(dim=axis, keepdim=True, unbiased=False)
    return (x - m) / torch.sqrt(v + eps)
def _scatter_add(tgt, idx, src, axis=0):
    return tgt.clone().index_add_(axis, idx, src)
def _segment_sum(src, seg, n):
    out = torch.zeros((n,) + src.shape[1:], dtype=src.dtype)
    return out.index_add_(0, seg, src)
def _pad(x, pw):
    flat = tuple(v for pair in reversed(pw) for v in pair)
    return torch.nn.functional.pad(x, flat)

kernel_name = 'recurrent_scan__gqa_block_cached__glu_gated_reglu__decode'

def setup_inputs():

    _w = (lambda a: (lambda t: t.to(torch.bfloat16) if t.is_floating_point() else t)(torch.as_tensor(a)))
    def _A_setup():
        B, Sq, D = 2, 1, 576
        Hq, Hkv, Sk, Dh = 32, 16, 32768, 128
        assert Hq % Hkv == 0, (Hq, Hkv)
        return {
            "x": _w((lambda *s: torch.randn(*s, dtype=torch.bfloat16) * 0.4)(B, Sq, D)),
            "k_cache": _w((lambda *s: torch.randn(*s, dtype=torch.bfloat16) * 1.6)(B, Hkv, Sk, Dh)),
            "v_cache": _w((lambda *s: torch.randn(*s, dtype=torch.bfloat16) * 1.6)(B, Hkv, Sk, Dh)),
            "wq": _w((lambda *s: torch.randn(*s, dtype=torch.bfloat16) * 1.6)(D, Hq * Dh) * (D ** -0.5)),
            "wo": _w((lambda *s: torch.randn(*s, dtype=torch.bfloat16) * 1.6)(Hq * Dh, D) * ((Hq * Dh) ** -0.5)),
        }
    _A_in = _A_setup()

    def _B_setup():
        B, S, D, F = 2, 1, 576, 4608
        return {
            "x": _w((lambda *s: torch.randn(*s, dtype=torch.bfloat16) * 0.4)(B, S, D)),
            "W_gate": _w((lambda *s: torch.randn(*s, dtype=torch.bfloat16) * 1.6)(D, F) * (2.0 / D) ** 0.5),
            "W_up": _w((lambda *s: torch.randn(*s, dtype=torch.bfloat16) * 1.6)(D, F) * (2.0 / D) ** 0.5),
            "W_down": _w((lambda *s: torch.randn(*s, dtype=torch.bfloat16) * 1.6)(F, D) * (1.0 / F) ** 0.5),
        }
    _B_in = _B_setup()

    return {
        "A_x": _A_in["x"],
        "A_k_cache": _A_in["k_cache"],
        "A_v_cache": _A_in["v_cache"],
        "A_wq": _A_in["wq"],
        "A_wo": _A_in["wo"],
        "B_x": _B_in["x"],
        "B_W_gate": _B_in["W_gate"],
        "B_W_up": _B_in["W_up"],
        "B_W_down": _B_in["W_down"],
    }

def reference(A_x, A_k_cache, A_v_cache, A_wq, A_wo, B_x, B_W_gate, B_W_up, B_W_down):
    def _A_ref(x, k_cache, v_cache, wq, wo):
        B, Sq, D = x.shape
        Hq, Dh = 32, 128
        Hkv = k_cache.shape[1]
        rep = Hq // Hkv
        q = (lambda x, *d: x.permute(*d))((x @ wq).reshape(B, Sq, Hq, Dh), 0, 2, 1, 3)
        k = (lambda x, n, axis: torch.repeat_interleave(x, n, dim=axis))(k_cache, rep, axis=1)
        v = (lambda x, n, axis: torch.repeat_interleave(x, n, dim=axis))(v_cache, rep, axis=1)
        scores = torch.einsum("bhqd,bhkd->bhqk", q, k) * (Dh ** -0.5)
        p = _softmax(scores, axis=-1)
        o = torch.einsum("bhqk,bhkd->bhqd", p, v)
        return (lambda x, *d: x.permute(*d))(o, 0, 2, 1, 3).reshape(B, Sq, Hq * Dh) @ wo

    def _B_ref(x, W_gate, W_up, W_down):
        gate = torch.einsum("bsd,df->bsf", x, W_gate)
        up = torch.einsum("bsd,df->bsf", x, W_up)
        gate = gate * (lambda x, dt: x.to(dt))(gate > 0, gate.dtype)
        h = gate * up
        return torch.einsum("bsf,fd->bsd", h, W_down)

    x = A_x
    xn = _layernorm(x, axis=-1)
    s = _A_ref(xn, A_k_cache, A_v_cache, A_wq, A_wo)
    g = _silu(_B_ref(xn, B_W_gate, B_W_up, B_W_down))
    return x + s * g
```

```asm
; @launch grid=(256,1,1) block=(512,1,1) lds=45632
.amdgcn_target "amdgcn-amd-amdhsa--gfx950"
.text
.p2align 12
.globl recurrent_scan__gqa_block_cached__glu_gated_reglu__decode_kernel
.p2align 8
.type recurrent_scan__gqa_block_cached__glu_gated_reglu__decode_kernel,@function
recurrent_scan__gqa_block_cached__glu_gated_reglu__decode_kernel:
    s_cmp_ge_u32 s2, 256
    s_cbranch_scc1 L_end
    s_load_dwordx16 s[8:23], s[0:1], 0
    s_load_dwordx8 s[24:31], s[0:1], 64
    v_lshrrev_b32 v1, 6, v0
    v_lshlrev_b32 v2, 2, v0
    v_mov_b32 v3, 0
    v_readfirstlane_b32 s3, v1
    ds_write_b32 v2, v3 offset:43584
    v_and_b32 v0, 63, v0
    s_bfe_u32 s4, s2, 0x40003
    s_lshr_b32 s5, s2, 7
    s_and_b32 s6, s2, 7
    s_lshr_b32 s7, s2, 3
    s_cmp_ge_u32 s3, 4
    s_cbranch_scc1 L_helper
    v_bfe_u32 v1, v0, 1, 1
    v_lshlrev_b32 v1, 2, v1
    v_bfe_u32 v2, v0, 2, 2
    v_or_b32 v1, v1, v2
    v_lshlrev_b32 v1, 8, v1
    v_lshrrev_b32 v2, 4, v0
    v_lshl_or_b32 v1, v2, 5, v1
    v_and_b32 v2, 1, v0
    v_lshl_or_b32 v1, v2, 4, v1
    s_lshl_b32 s34, s7, 23
    s_lshl_b32 s35, s3, 13
    s_add_u32 s34, s34, s35
    s_lshl_b32 s35, s6, 20
    s_add_u32 s34, s34, s35
    s_add_u32 s34, s34, 4096
    s_waitcnt lgkmcnt(0)
    s_add_u32 s32, s10, s34
    s_addc_u32 s33, s11, 0
    global_load_dwordx4 v[96:99], v1, s[32:33] offset:-4096 nt
    global_load_dwordx4 v[100:103], v1, s[32:33] offset:-3968 nt
    global_load_dwordx4 v[104:107], v1, s[32:33] offset:-2048 nt
    global_load_dwordx4 v[108:111], v1, s[32:33] offset:-1920 nt
    global_load_dwordx4 v[112:115], v1, s[32:33] offset:0 nt
    s_load_dword s53, s[30:31], 1048320
    s_barrier
    v_lshlrev_b32 v2, 4, v0
    s_lshl_b32 s40, s3, 8
    s_mul_i32 s35, s3, 7936
    v_lshl_add_u32 v21, v0, 2, s40
    v_add_u32 v3, s35, v21
    v_mov_b32 v17, 0xffff
    v_and_b32 v16, 1, v0
    v_lshlrev_b32 v16, 4, v16
    v_lshlrev_b32 v16, v16, v17
    v_bfe_u32 v17, v0, 1, 2
    v_cmp_eq_u32 vcc, 0, v17
    s_nop 1
    v_cndmask_b32 v4, 0, v16, vcc
    v_cmp_eq_u32 vcc, 1, v17
    s_nop 1
    v_cndmask_b32 v5, 0, v16, vcc
    v_cmp_eq_u32 vcc, 2, v17
    s_nop 1
    v_cndmask_b32 v6, 0, v16, vcc
    v_cmp_eq_u32 vcc, 3, v17
    s_nop 1
    v_cndmask_b32 v7, 0, v16, vcc
    v_mov_b32 v32, 0
    v_mov_b32 v33, 0
    v_mov_b32 v34, 0
    v_mov_b32 v35, 0
    v_mov_b32 v36, 0
    v_mov_b32 v37, 0
    v_mov_b32 v38, 0
    v_mov_b32 v39, 0
    v_mov_b32 v40, 0
    v_mov_b32 v41, 0
    v_mov_b32 v42, 0
    v_mov_b32 v43, 0
    v_mov_b32 v44, 0
    v_mov_b32 v45, 0
    v_mov_b32 v46, 0
    v_mov_b32 v47, 0
    v_mov_b32 v48, 0
    v_mov_b32 v49, 0
    v_mov_b32 v50, 0
    v_mov_b32 v51, 0
    v_mov_b32 v52, 0
    v_mov_b32 v53, 0
    v_mov_b32 v54, 0
    v_mov_b32 v55, 0
    v_mov_b32 v56, 0
    v_mov_b32 v57, 0
    v_mov_b32 v58, 0
    v_mov_b32 v59, 0
    v_mov_b32 v60, 0
    v_mov_b32 v61, 0
    v_mov_b32 v62, 0
    v_mov_b32 v63, 0
    v_mov_b32 v18, 0xff800000
    v_and_b32 v16, 1, v0
    v_lshlrev_b32 v16, 8, v16
    v_lshrrev_b32 v17, 4, v0
    v_lshl_or_b32 v16, v17, 5, v16
    s_lshl_b32 s40, s4, 11
    s_lshl_b32 s41, s5, 8
    s_add_u32 s40, s40, s41
    s_add_u32 s40, s40, 1310720
    s_mov_b32 s41, 0x07060302
    v_lshl_add_u32 v24, v17, 8, v2
    v_add_u32 v24, s40, v24
    v_and_b32 v25, 7, v0
    v_lshlrev_b32 v25, 4, v25
    v_lshl_or_b32 v25, v17, 7, v25
    v_and_or_b32 v25, v0, 8, v25
    v_bfe_u32 v17, v0, 3, 1
    v_lshl_or_b32 v16, v17, 4, v16
    s_waitcnt vmcnt(4)
    global_load_dwordx4 v[116:119], v1, s[32:33] offset:128 nt
    s_waitcnt vmcnt(4)
    global_load_dwordx4 v[120:123], v1, s[32:33] offset:2048 nt
    s_waitcnt vmcnt(4)
    global_load_dwordx4 v[124:127], v1, s[32:33] offset:2176 nt
    s_waitcnt vmcnt(4)
    s_add_u32 s32, s32, 0x8000
    s_addc_u32 s33, s33, 0
    global_load_dwordx4 v[128:131], v1, s[32:33] offset:-4096 nt
    s_waitcnt vmcnt(4)
    global_load_dwordx4 v[132:135], v1, s[32:33] offset:-3968 nt
    s_waitcnt vmcnt(4)
    global_load_dwordx4 v[136:139], v1, s[32:33] offset:-2048 nt
    s_waitcnt vmcnt(4)
    global_load_dwordx4 v[140:143], v1, s[32:33] offset:-1920 nt
    s_waitcnt vmcnt(4)
    global_load_dwordx4 v[144:147], v1, s[32:33] offset:0 nt
    s_waitcnt vmcnt(4)
    global_load_dwordx4 v[148:151], v1, s[32:33] offset:128 nt
    s_waitcnt vmcnt(4)
    global_load_dwordx4 v[152:155], v1, s[32:33] offset:2048 nt
    s_waitcnt vmcnt(4)
    global_load_dwordx4 v[156:159], v1, s[32:33] offset:2176 nt
    s_waitcnt vmcnt(4)
    s_add_u32 s32, s32, 0x8000
    s_addc_u32 s33, s33, 0
    global_load_dwordx4 v[160:163], v1, s[32:33] offset:-4096 nt
    s_waitcnt vmcnt(4)
    global_load_dwordx4 v[164:167], v1, s[32:33] offset:-3968 nt
    s_waitcnt vmcnt(4)
    global_load_dwordx4 v[168:171], v1, s[32:33] offset:-2048 nt
    s_waitcnt vmcnt(4)
    global_load_dwordx4 v[172:175], v1, s[32:33] offset:-1920 nt
    s_waitcnt vmcnt(4)
    global_load_dwordx4 v[176:179], v1, s[32:33] offset:0 nt
    s_waitcnt vmcnt(4)
    global_load_dwordx4 v[180:183], v1, s[32:33] offset:128 nt
    s_waitcnt vmcnt(4)
    global_load_dwordx4 v[184:187], v1, s[32:33] offset:2048 nt
    s_waitcnt vmcnt(4)
    global_load_dwordx4 v[188:191], v1, s[32:33] offset:2176 nt
    s_waitcnt vmcnt(4)
    s_add_u32 s32, s32, 0x8000
    s_addc_u32 s33, s33, 0
    global_load_dwordx4 v[192:195], v1, s[32:33] offset:-4096 nt
    s_waitcnt vmcnt(4)
    global_load_dwordx4 v[196:199], v1, s[32:33] offset:-3968 nt
    s_waitcnt vmcnt(4)
    global_load_dwordx4 v[200:203], v1, s[32:33] offset:-2048 nt
    s_waitcnt vmcnt(4)
    global_load_dwordx4 v[204:207], v1, s[32:33] offset:-1920 nt
    s_waitcnt vmcnt(4)
    global_load_dwordx4 v[208:211], v1, s[32:33] offset:0 nt
    s_waitcnt vmcnt(4)
    global_load_dwordx4 v[212:215], v1, s[32:33] offset:128 nt
    s_waitcnt vmcnt(4)
    global_load_dwordx4 v[216:219], v1, s[32:33] offset:2048 nt
    s_waitcnt vmcnt(4)
    global_load_dwordx4 v[220:223], v1, s[32:33] offset:2176 nt
    s_waitcnt vmcnt(4)
    s_add_u32 s32, s32, 0x8000
    s_addc_u32 s33, s33, 0
    global_load_dwordx4 v[224:227], v1, s[32:33] offset:-4096 nt
    s_waitcnt vmcnt(4)
    global_load_dwordx4 v[228:231], v1, s[32:33] offset:-3968 nt
    s_waitcnt vmcnt(4)
    global_load_dwordx4 v[232:235], v1, s[32:33] offset:-2048 nt
    s_waitcnt vmcnt(4)
    global_load_dwordx4 v[236:239], v1, s[32:33] offset:-1920 nt
    s_waitcnt vmcnt(4)
    global_load_dwordx4 v[240:243], v1, s[32:33] offset:0 nt
    s_waitcnt vmcnt(4)
    global_load_dwordx4 v[244:247], v1, s[32:33] offset:128 nt
    s_waitcnt vmcnt(4)
    global_load_dwordx4 v[248:251], v1, s[32:33] offset:2048 nt
    s_waitcnt lgkmcnt(0)
    s_mul_i32 s54, s53, 0x9e3779b1
    s_add_u32 s54, s54, 0x7f4a7c15
    s_and_b32 s76, s54, 0xff
    s_bfe_u32 s77, s54, 0x80008
    s_bfe_u32 s78, s54, 0x80010
    s_lshr_b32 s79, s54, 24
    s_and_b32 s80, s54, 0xffff
    s_waitcnt vmcnt(4)
    global_load_dwordx4 v[252:255], v1, s[32:33] offset:2176 nt
    s_waitcnt vmcnt(4)
    global_load_dwordx4 v[8:11], v24, s[30:31] sc1
    s_waitcnt vmcnt(4)
    s_add_u32 s32, s32, 0x8000
    s_addc_u32 s33, s33, 0
    global_load_dwordx4 v[64:67], v1, s[32:33] offset:-4096 nt
    s_waitcnt vmcnt(4)
    global_load_dwordx4 v[68:71], v1, s[32:33] offset:-3968 nt
    s_waitcnt vmcnt(4)
    global_load_dwordx4 v[72:75], v1, s[32:33] offset:-2048 nt
    s_waitcnt vmcnt(4)
    global_load_dwordx4 v[76:79], v1, s[32:33] offset:-1920 nt
    s_waitcnt vmcnt(4)
    global_load_dwordx4 v[80:83], v1, s[32:33] offset:0 nt
    v_xor_b32 v8, s80, v8
    v_xor_b32 v9, s80, v9
    v_xor_b32 v10, s80, v10
    v_xor_b32 v11, s80, v11
    v_or3_b32 v17, v8, v9, v10
    v_or_b32 v17, v17, v11
    v_and_b32 v17, 65535, v17
    v_cmp_ne_u32 vcc, 0, v17
    s_cbranch_vccnz L_gqs
L_gqok:
    v_perm_b32 v8, v9, v8, s41
    v_perm_b32 v9, v11, v10, s41
    ds_write_b64 v25, v[8:9] offset:37376
    s_mov_b32 exec_lo, 0x3030303
    s_mov_b32 exec_hi, 0x3030303
    ds_read_b128 v[32:35], v16 offset:37376
    ds_read_b128 v[36:39], v16 offset:37504
    s_mov_b32 exec_lo, 0xc0c0c0c
    s_mov_b32 exec_hi, 0xc0c0c0c
    ds_read_b128 v[40:43], v16 offset:37376
    ds_read_b128 v[44:47], v16 offset:37504
    s_mov_b32 exec_lo, 0x30303030
    s_mov_b32 exec_hi, 0x30303030
    ds_read_b128 v[48:51], v16 offset:37376
    ds_read_b128 v[52:55], v16 offset:37504
    s_mov_b32 exec_lo, 0xc0c0c0c0
    s_mov_b32 exec_hi, 0xc0c0c0c0
    ds_read_b128 v[56:59], v16 offset:37376
    ds_read_b128 v[60:63], v16 offset:37504
    s_mov_b64 exec, -1
    s_waitcnt vmcnt(4)
    global_load_dwordx4 v[84:87], v1, s[32:33] offset:128 nt
    s_waitcnt vmcnt(4)
    global_load_dwordx4 v[88:91], v1, s[32:33] offset:2048 nt
    s_waitcnt lgkmcnt(0)
    s_waitcnt vmcnt(4)
    global_load_dwordx4 v[92:95], v1, s[32:33] offset:2176 nt
    v_mfma_f32_16x16x32_bf16 v[8:11], v[64:67], v[32:35], 0
    v_mfma_f32_16x16x32_bf16 v[12:15], v[96:99], v[32:35], 0
    s_add_u32 s32, s32, 0x8000
    s_addc_u32 s33, s33, 0
    s_waitcnt vmcnt(4)
    global_load_dwordx4 v[64:67], v1, s[32:33] offset:-4096 nt
    v_mfma_f32_16x16x32_bf16 v[8:11], v[68:71], v[36:39], v[8:11]
    v_mfma_f32_16x16x32_bf16 v[12:15], v[100:103], v[36:39], v[12:15]
    s_waitcnt vmcnt(4)
    global_load_dwordx4 v[68:71], v1, s[32:33] offset:-3968 nt
    v_mfma_f32_16x16x32_bf16 v[8:11], v[72:75], v[40:43], v[8:11]
    v_mfma_f32_16x16x32_bf16 v[12:15], v[104:107], v[40:43], v[12:15]
    s_waitcnt vmcnt(4)
    global_load_dwordx4 v[72:75], v1, s[32:33] offset:-2048 nt
    v_mfma_f32_16x16x32_bf16 v[8:11], v[76:79], v[44:47], v[8:11]
    v_mfma_f32_16x16x32_bf16 v[12:15], v[108:111], v[44:47], v[12:15]
    s_waitcnt vmcnt(4)
    global_load_dwordx4 v[76:79], v1, s[32:33] offset:-1920 nt
    v_mfma_f32_16x16x32_bf16 v[8:11], v[80:83], v[48:51], v[8:11]
    v_mfma_f32_16x16x32_bf16 v[12:15], v[112:115], v[48:51], v[12:15]
    s_waitcnt vmcnt(4)
    global_load_dwordx4 v[80:83], v1, s[32:33] offset:0 nt
    v_mfma_f32_16x16x32_bf16 v[8:11], v[84:87], v[52:55], v[8:11]
    v_mfma_f32_16x16x32_bf16 v[12:15], v[116:119], v[52:55], v[12:15]
    s_waitcnt vmcnt(4)
    global_load_dwordx4 v[84:87], v1, s[32:33] offset:128 nt
    v_mfma_f32_16x16x32_bf16 v[8:11], v[88:91], v[56:59], v[8:11]
    v_mfma_f32_16x16x32_bf16 v[12:15], v[120:123], v[56:59], v[12:15]
    s_waitcnt vmcnt(4)
    global_load_dwordx4 v[88:91], v1, s[32:33] offset:2048 nt
    v_mfma_f32_16x16x32_bf16 v[8:11], v[92:95], v[60:63], v[8:11]
    v_mfma_f32_16x16x32_bf16 v[12:15], v[124:127], v[60:63], v[12:15]
    s_nop 6
    v_add_f32_dpp v16, v9, v8 row_ror:8 row_mask:0xf bank_mask:0x3
    s_nop 1
    v_add_f32_dpp v16, v10, v11 row_ror:8 row_mask:0xf bank_mask:0xc
    v_cvt_pk_bf16_f32 v16, v16, v16
    v_and_b32 v16, 0xffff0000, v16
    v_mul_f32 v16, 0x3db504f3, v16
    v_cvt_pk_bf16_f32 v16, v16, v16
    v_and_b32 v16, 0xffff0000, v16
    v_max_f32 v18, v18, v16
    ds_write_b32 v3, v16 offset:1280
    v_add_f32_dpp v16, v13, v12 row_ror:8 row_mask:0xf bank_mask:0x3
    s_nop 1
    v_add_f32_dpp v16, v14, v15 row_ror:8 row_mask:0xf bank_mask:0xc
    v_cvt_pk_bf16_f32 v16, v16, v16
    v_and_b32 v16, 0xffff0000, v16
    v_mul_f32 v16, 0x3db504f3, v16
    v_cvt_pk_bf16_f32 v16, v16, v16
    v_and_b32 v16, 0xffff0000, v16
    v_max_f32 v18, v18, v16
    ds_write_b32 v3, v16 offset:0
    v_add_u32 v3, 0x100, v3
    s_waitcnt vmcnt(4)
    global_load_dwordx4 v[92:95], v1, s[32:33] offset:2176 nt
    v_mfma_f32_16x16x32_bf16 v[8:11], v[64:67], v[32:35], 0
    v_mfma_f32_16x16x32_bf16 v[12:15], v[128:131], v[32:35], 0
    s_add_u32 s32, s32, 0x8000
    s_addc_u32 s33, s33, 0
    s_waitcnt vmcnt(4)
    global_load_dwordx4 v[64:67], v1, s[32:33] offset:-4096 nt
    v_mfma_f32_16x16x32_bf16 v[8:11], v[68:71], v[36:39], v[8:11]
    v_mfma_f32_16x16x32_bf16 v[12:15], v[132:135], v[36:39], v[12:15]
    s_waitcnt vmcnt(4)
    global_load_dwordx4 v[68:71], v1, s[32:33] offset:-3968 nt
    v_mfma_f32_16x16x32_bf16 v[8:11], v[72:75], v[40:43], v[8:11]
    v_mfma_f32_16x16x32_bf16 v[12:15], v[136:139], v[40:43], v[12:15]
    s_waitcnt vmcnt(4)
    global_load_dwordx4 v[72:75], v1, s[32:33] offset:-2048 nt
    v_mfma_f32_16x16x32_bf16 v[8:11], v[76:79], v[44:47], v[8:11]
    v_mfma_f32_16x16x32_bf16 v[12:15], v[140:143], v[44:47], v[12:15]
    s_waitcnt vmcnt(4)
    global_load_dwordx4 v[76:79], v1, s[32:33] offset:-1920 nt
    v_mfma_f32_16x16x32_bf16 v[8:11], v[80:83], v[48:51], v[8:11]
    v_mfma_f32_16x16x32_bf16 v[12:15], v[144:147], v[48:51], v[12:15]
    s_waitcnt vmcnt(4)
    global_load_dwordx4 v[80:83], v1, s[32:33] offset:0 nt
    v_mfma_f32_16x16x32_bf16 v[8:11], v[84:87], v[52:55], v[8:11]
    v_mfma_f32_16x16x32_bf16 v[12:15], v[148:151], v[52:55], v[12:15]
    s_waitcnt vmcnt(4)
    global_load_dwordx4 v[84:87], v1, s[32:33] offset:128 nt
    v_mfma_f32_16x16x32_bf16 v[8:11], v[88:91], v[56:59], v[8:11]
    v_mfma_f32_16x16x32_bf16 v[12:15], v[152:155], v[56:59], v[12:15]
    s_waitcnt vmcnt(4)
    global_load_dwordx4 v[88:91], v1, s[32:33] offset:2048 nt
    v_mfma_f32_16x16x32_bf16 v[8:11], v[92:95], v[60:63], v[8:11]
    v_mfma_f32_16x16x32_bf16 v[12:15], v[156:159], v[60:63], v[12:15]
    s_nop 6
    v_add_f32_dpp v16, v9, v8 row_ror:8 row_mask:0xf bank_mask:0x3
    s_nop 1
    v_add_f32_dpp v16, v10, v11 row_ror:8 row_mask:0xf bank_mask:0xc
    v_cvt_pk_bf16_f32 v16, v16, v16
    v_and_b32 v16, 0xffff0000, v16
    v_mul_f32 v16, 0x3db504f3, v16
    v_cvt_pk_bf16_f32 v16, v16, v16
    v_and_b32 v16, 0xffff0000, v16
    v_max_f32 v18, v18, v16
    ds_write_b32 v3, v16 offset:1280
    v_add_f32_dpp v16, v13, v12 row_ror:8 row_mask:0xf bank_mask:0x3
    s_nop 1
    v_add_f32_dpp v16, v14, v15 row_ror:8 row_mask:0xf bank_mask:0xc
    v_cvt_pk_bf16_f32 v16, v16, v16
    v_and_b32 v16, 0xffff0000, v16
    v_mul_f32 v16, 0x3db504f3, v16
    v_cvt_pk_bf16_f32 v16, v16, v16
    v_and_b32 v16, 0xffff0000, v16
    v_max_f32 v18, v18, v16
    ds_write_b32 v3, v16 offset:0
    v_add_u32 v3, 0x100, v3
    s_waitcnt vmcnt(4)
    global_load_dwordx4 v[92:95], v1, s[32:33] offset:2176 nt
    v_mfma_f32_16x16x32_bf16 v[8:11], v[64:67], v[32:35], 0
    v_mfma_f32_16x16x32_bf16 v[12:15], v[160:163], v[32:35], 0
    s_add_u32 s32, s32, 0x8000
    s_addc_u32 s33, s33, 0
    s_waitcnt vmcnt(4)
    global_load_dwordx4 v[64:67], v1, s[32:33] offset:-4096 nt
    v_mfma_f32_16x16x32_bf16 v[8:11], v[68:71], v[36:39], v[8:11]
    v_mfma_f32_16x16x32_bf16 v[12:15], v[164:167], v[36:39], v[12:15]
    s_waitcnt vmcnt(4)
    global_load_dwordx4 v[68:71], v1, s[32:33] offset:-3968 nt
    v_mfma_f32_16x16x32_bf16 v[8:11], v[72:75], v[40:43], v[8:11]
    v_mfma_f32_16x16x32_bf16 v[12:15], v[168:171], v[40:43], v[12:15]
    s_waitcnt vmcnt(4)
    global_load_dwordx4 v[72:75], v1, s[32:33] offset:-2048 nt
    v_mfma_f32_16x16x32_bf16 v[8:11], v[76:79], v[44:47], v[8:11]
    v_mfma_f32_16x16x32_bf16 v[12:15], v[172:175], v[44:47], v[12:15]
    s_waitcnt vmcnt(4)
    global_load_dwordx4 v[76:79], v1, s[32:33] offset:-1920 nt
    v_mfma_f32_16x16x32_bf16 v[8:11], v[80:83], v[48:51], v[8:11]
    v_mfma_f32_16x16x32_bf16 v[12:15], v[176:179], v[48:51], v[12:15]
    s_waitcnt vmcnt(4)
    global_load_dwordx4 v[80:83], v1, s[32:33] offset:0 nt
    v_mfma_f32_16x16x32_bf16 v[8:11], v[84:87], v[52:55], v[8:11]
    v_mfma_f32_16x16x32_bf16 v[12:15], v[180:183], v[52:55], v[12:15]
    s_waitcnt vmcnt(4)
    global_load_dwordx4 v[84:87], v1, s[32:33] offset:128 nt
    v_mfma_f32_16x16x32_bf16 v[8:11], v[88:91], v[56:59], v[8:11]
    v_mfma_f32_16x16x32_bf16 v[12:15], v[184:187], v[56:59], v[12:15]
    s_waitcnt vmcnt(4)
    global_load_dwordx4 v[88:91], v1, s[32:33] offset:2048 nt
    v_mfma_f32_16x16x32_bf16 v[8:11], v[92:95], v[60:63], v[8:11]
    v_mfma_f32_16x16x32_bf16 v[12:15], v[188:191], v[60:63], v[12:15]
    s_nop 6
    v_add_f32_dpp v16, v9, v8 row_ror:8 row_mask:0xf bank_mask:0x3
    s_nop 1
    v_add_f32_dpp v16, v10, v11 row_ror:8 row_mask:0xf bank_mask:0xc
    v_cvt_pk_bf16_f32 v16, v16, v16
    v_and_b32 v16, 0xffff0000, v16
    v_mul_f32 v16, 0x3db504f3, v16
    v_cvt_pk_bf16_f32 v16, v16, v16
    v_and_b32 v16, 0xffff0000, v16
    v_max_f32 v18, v18, v16
    ds_write_b32 v3, v16 offset:1280
    v_add_f32_dpp v16, v13, v12 row_ror:8 row_mask:0xf bank_mask:0x3
    s_nop 1
    v_add_f32_dpp v16, v14, v15 row_ror:8 row_mask:0xf bank_mask:0xc
    v_cvt_pk_bf16_f32 v16, v16, v16
    v_and_b32 v16, 0xffff0000, v16
    v_mul_f32 v16, 0x3db504f3, v16
    v_cvt_pk_bf16_f32 v16, v16, v16
    v_and_b32 v16, 0xffff0000, v16
    v_max_f32 v18, v18, v16
    ds_write_b32 v3, v16 offset:0
    v_add_u32 v3, 0x100, v3
    s_waitcnt vmcnt(4)
    global_load_dwordx4 v[92:95], v1, s[32:33] offset:2176 nt
    v_mfma_f32_16x16x32_bf16 v[8:11], v[64:67], v[32:35], 0
    v_mfma_f32_16x16x32_bf16 v[12:15], v[192:195], v[32:35], 0
    s_add_u32 s32, s32, 0x8000
    s_addc_u32 s33, s33, 0
    s_waitcnt vmcnt(4)
    global_load_dwordx4 v[64:67], v1, s[32:33] offset:-4096 nt
    v_mfma_f32_16x16x32_bf16 v[8:11], v[68:71], v[36:39], v[8:11]
    v_mfma_f32_16x16x32_bf16 v[12:15], v[196:199], v[36:39], v[12:15]
    s_waitcnt vmcnt(4)
    global_load_dwordx4 v[68:71], v1, s[32:33] offset:-3968 nt
    v_mfma_f32_16x16x32_bf16 v[8:11], v[72:75], v[40:43], v[8:11]
    v_mfma_f32_16x16x32_bf16 v[12:15], v[200:203], v[40:43], v[12:15]
    s_waitcnt vmcnt(4)
    global_load_dwordx4 v[72:75], v1, s[32:33] offset:-2048 nt
    v_mfma_f32_16x16x32_bf16 v[8:11], v[76:79], v[44:47], v[8:11]
    v_mfma_f32_16x16x32_bf16 v[12:15], v[204:207], v[44:47], v[12:15]
    s_waitcnt vmcnt(4)
    global_load_dwordx4 v[76:79], v1, s[32:33] offset:-1920 nt
    v_mfma_f32_16x16x32_bf16 v[8:11], v[80:83], v[48:51], v[8:11]
    v_mfma_f32_16x16x32_bf16 v[12:15], v[208:211], v[48:51], v[12:15]
    s_waitcnt vmcnt(4)
    global_load_dwordx4 v[80:83], v1, s[32:33] offset:0 nt
    v_mfma_f32_16x16x32_bf16 v[8:11], v[84:87], v[52:55], v[8:11]
    v_mfma_f32_16x16x32_bf16 v[12:15], v[212:215], v[52:55], v[12:15]
    s_waitcnt vmcnt(4)
    global_load_dwordx4 v[84:87], v1, s[32:33] offset:128 nt
    v_mfma_f32_16x16x32_bf16 v[8:11], v[88:91], v[56:59], v[8:11]
    v_mfma_f32_16x16x32_bf16 v[12:15], v[216:219], v[56:59], v[12:15]
    s_waitcnt vmcnt(4)
    global_load_dwordx4 v[88:91], v1, s[32:33] offset:2048 nt
    v_mfma_f32_16x16x32_bf16 v[8:11], v[92:95], v[60:63], v[8:11]
    v_mfma_f32_16x16x32_bf16 v[12:15], v[220:223], v[60:63], v[12:15]
    s_nop 6
    v_add_f32_dpp v16, v9, v8 row_ror:8 row_mask:0xf bank_mask:0x3
    s_nop 1
    v_add_f32_dpp v16, v10, v11 row_ror:8 row_mask:0xf bank_mask:0xc
    v_cvt_pk_bf16_f32 v16, v16, v16
    v_and_b32 v16, 0xffff0000, v16
    v_mul_f32 v16, 0x3db504f3, v16
    v_cvt_pk_bf16_f32 v16, v16, v16
    v_and_b32 v16, 0xffff0000, v16
    v_max_f32 v18, v18, v16
    ds_write_b32 v3, v16 offset:1280
    v_add_f32_dpp v16, v13, v12 row_ror:8 row_mask:0xf bank_mask:0x3
    s_nop 1
    v_add_f32_dpp v16, v14, v15 row_ror:8 row_mask:0xf bank_mask:0xc
    v_cvt_pk_bf16_f32 v16, v16, v16
    v_and_b32 v16, 0xffff0000, v16
    v_mul_f32 v16, 0x3db504f3, v16
    v_cvt_pk_bf16_f32 v16, v16, v16
    v_and_b32 v16, 0xffff0000, v16
    v_max_f32 v18, v18, v16
    ds_write_b32 v3, v16 offset:0
    v_add_u32 v3, 0x100, v3
    s_waitcnt vmcnt(4)
    global_load_dwordx4 v[92:95], v1, s[32:33] offset:2176 nt
    v_mfma_f32_16x16x32_bf16 v[8:11], v[64:67], v[32:35], 0
    v_mfma_f32_16x16x32_bf16 v[12:15], v[224:227], v[32:35], 0
    s_add_u32 s32, s32, 0x8000
    s_addc_u32 s33, s33, 0
    s_waitcnt vmcnt(4)
    global_load_dwordx4 v[64:67], v1, s[32:33] offset:-4096 nt
    v_mfma_f32_16x16x32_bf16 v[8:11], v[68:71], v[36:39], v[8:11]
    v_mfma_f32_16x16x32_bf16 v[12:15], v[228:231], v[36:39], v[12:15]
    s_waitcnt vmcnt(4)
    global_load_dwordx4 v[68:71], v1, s[32:33] offset:-3968 nt
    v_mfma_f32_16x16x32_bf16 v[8:11], v[72:75], v[40:43], v[8:11]
    v_mfma_f32_16x16x32_bf16 v[12:15], v[232:235], v[40:43], v[12:15]
    s_waitcnt vmcnt(4)
    global_load_dwordx4 v[72:75], v1, s[32:33] offset:-2048 nt
    v_mfma_f32_16x16x32_bf16 v[8:11], v[76:79], v[44:47], v[8:11]
    v_mfma_f32_16x16x32_bf16 v[12:15], v[236:239], v[44:47], v[12:15]
    s_waitcnt vmcnt(4)
    global_load_dwordx4 v[76:79], v1, s[32:33] offset:-1920 nt
    v_mfma_f32_16x16x32_bf16 v[8:11], v[80:83], v[48:51], v[8:11]
    v_mfma_f32_16x16x32_bf16 v[12:15], v[240:243], v[48:51], v[12:15]
    s_waitcnt vmcnt(4)
    global_load_dwordx4 v[80:83], v1, s[32:33] offset:0 nt
    v_mfma_f32_16x16x32_bf16 v[8:11], v[84:87], v[52:55], v[8:11]
    v_mfma_f32_16x16x32_bf16 v[12:15], v[244:247], v[52:55], v[12:15]
    s_waitcnt vmcnt(4)
    global_load_dwordx4 v[84:87], v1, s[32:33] offset:128 nt
    v_mfma_f32_16x16x32_bf16 v[8:11], v[88:91], v[56:59], v[8:11]
    v_mfma_f32_16x16x32_bf16 v[12:15], v[248:251], v[56:59], v[12:15]
    s_waitcnt vmcnt(4)
    global_load_dwordx4 v[88:91], v1, s[32:33] offset:2048 nt
    v_mfma_f32_16x16x32_bf16 v[8:11], v[92:95], v[60:63], v[8:11]
    v_mfma_f32_16x16x32_bf16 v[12:15], v[252:255], v[60:63], v[12:15]
    s_nop 6
    v_add_f32_dpp v16, v9, v8 row_ror:8 row_mask:0xf bank_mask:0x3
    s_nop 1
    v_add_f32_dpp v16, v10, v11 row_ror:8 row_mask:0xf bank_mask:0xc
    v_cvt_pk_bf16_f32 v16, v16, v16
    v_and_b32 v16, 0xffff0000, v16
    v_mul_f32 v16, 0x3db504f3, v16
    v_cvt_pk_bf16_f32 v16, v16, v16
    v_and_b32 v16, 0xffff0000, v16
    v_max_f32 v18, v18, v16
    ds_write_b32 v3, v16 offset:1280
    v_add_f32_dpp v16, v13, v12 row_ror:8 row_mask:0xf bank_mask:0x3
    s_nop 1
    v_add_f32_dpp v16, v14, v15 row_ror:8 row_mask:0xf bank_mask:0xc
    v_cvt_pk_bf16_f32 v16, v16, v16
    v_and_b32 v16, 0xffff0000, v16
    v_mul_f32 v16, 0x3db504f3, v16
    v_cvt_pk_bf16_f32 v16, v16, v16
    v_and_b32 v16, 0xffff0000, v16
    v_max_f32 v18, v18, v16
    ds_write_b32 v3, v16 offset:0
    v_add_u32 v3, 0x100, v3
    v_mov_b32 v101, 0
    s_mov_b64 vcc, 0
    s_mov_b32 s58, 0
    s_mov_b32 s36, 10
L_kloop:
    s_waitcnt vmcnt(4)
    global_load_dwordx4 v[92:95], v1, s[32:33] offset:2176 nt
    v_mfma_f32_16x16x32_bf16 v[8:11], v[64:67], v[32:35], 0
    s_add_u32 s32, s32, 0x8000
    s_addc_u32 s33, s33, 0
    s_waitcnt vmcnt(4)
    global_load_dwordx4 v[64:67], v1, s[32:33] offset:-4096 nt
    v_mfma_f32_16x16x32_bf16 v[8:11], v[68:71], v[36:39], v[8:11]
    s_waitcnt vmcnt(4)
    global_load_dwordx4 v[68:71], v1, s[32:33] offset:-3968 nt
    v_mfma_f32_16x16x32_bf16 v[8:11], v[72:75], v[40:43], v[8:11]
    s_waitcnt vmcnt(4)
    global_load_dwordx4 v[72:75], v1, s[32:33] offset:-2048 nt
    v_mfma_f32_16x16x32_bf16 v[8:11], v[76:79], v[44:47], v[8:11]
    s_waitcnt vmcnt(4)
    global_load_dwordx4 v[76:79], v1, s[32:33] offset:-1920 nt
    v_mfma_f32_16x16x32_bf16 v[8:11], v[80:83], v[48:51], v[8:11]
    s_waitcnt vmcnt(4)
    global_load_dwordx4 v[80:83], v1, s[32:33] offset:0 nt
    v_mfma_f32_16x16x32_bf16 v[8:11], v[84:87], v[52:55], v[8:11]
    s_waitcnt vmcnt(4)
    global_load_dwordx4 v[84:87], v1, s[32:33] offset:128 nt
    v_mfma_f32_16x16x32_bf16 v[8:11], v[88:91], v[56:59], v[8:11]
    s_waitcnt vmcnt(4)
    global_load_dwordx4 v[88:91], v1, s[32:33] offset:2048 nt
    v_mfma_f32_16x16x32_bf16 v[8:11], v[92:95], v[60:63], v[8:11]
    s_nop 7
    v_add_f32_dpp v16, v9, v8 row_ror:8 row_mask:0xf bank_mask:0x3
    s_nop 1
    v_add_f32_dpp v16, v10, v11 row_ror:8 row_mask:0xf bank_mask:0xc
    v_cvt_pk_bf16_f32 v16, v16, v16
    v_and_b32 v16, 0xffff0000, v16
    v_mul_f32 v16, 0x3db504f3, v16
    v_cvt_pk_bf16_f32 v16, v16, v16
    v_and_b32 v16, 0xffff0000, v16
    v_max_f32 v18, v18, v16
    ds_write_b32 v3, v16 offset:1280
    v_add_u32 v3, 0x100, v3
    s_add_u32 s36, s36, 1
    s_cmp_lg_u32 s36, 31
    s_cbranch_scc1 L_kloop
    s_waitcnt vmcnt(4)
    global_load_dwordx4 v[92:95], v1, s[32:33] offset:2176 nt
    v_mfma_f32_16x16x32_bf16 v[8:11], v[64:67], v[32:35], 0
    s_add_u32 s32, s12, s34
    s_addc_u32 s33, s13, 0
    s_waitcnt vmcnt(4)
    global_load_dwordx4 v[64:67], v2, s[32:33] offset:-4096 nt
    v_mfma_f32_16x16x32_bf16 v[8:11], v[68:71], v[36:39], v[8:11]
    s_waitcnt vmcnt(4)
    global_load_dwordx4 v[68:71], v2, s[32:33] offset:-3072 nt
    v_mfma_f32_16x16x32_bf16 v[8:11], v[72:75], v[40:43], v[8:11]
    s_waitcnt vmcnt(4)
    global_load_dwordx4 v[72:75], v2, s[32:33] offset:-2048 nt
    v_mfma_f32_16x16x32_bf16 v[8:11], v[76:79], v[44:47], v[8:11]
    s_waitcnt vmcnt(4)
    global_load_dwordx4 v[76:79], v2, s[32:33] offset:-1024 nt
    v_mfma_f32_16x16x32_bf16 v[8:11], v[80:83], v[48:51], v[8:11]
    s_waitcnt vmcnt(4)
    global_load_dwordx4 v[80:83], v2, s[32:33] offset:0 nt
    v_mfma_f32_16x16x32_bf16 v[8:11], v[84:87], v[52:55], v[8:11]
    s_waitcnt vmcnt(4)
    global_load_dwordx4 v[84:87], v2, s[32:33] offset:1024 nt
    v_mfma_f32_16x16x32_bf16 v[8:11], v[88:91], v[56:59], v[8:11]
    s_waitcnt vmcnt(4)
    global_load_dwordx4 v[88:91], v2, s[32:33] offset:2048 nt
    v_mfma_f32_16x16x32_bf16 v[8:11], v[92:95], v[60:63], v[8:11]
    s_nop 7
    v_add_f32_dpp v16, v9, v8 row_ror:8 row_mask:0xf bank_mask:0x3
    s_nop 1
    v_add_f32_dpp v16, v10, v11 row_ror:8 row_mask:0xf bank_mask:0xc
    v_cvt_pk_bf16_f32 v16, v16, v16
    v_and_b32 v16, 0xffff0000, v16
    v_mul_f32 v16, 0x3db504f3, v16
    v_cvt_pk_bf16_f32 v16, v16, v16
    v_and_b32 v16, 0xffff0000, v16
    v_max_f32 v18, v18, v16
    ds_write_b32 v3, v16 offset:1280
    v_add_u32 v3, s35, v21
    ds_read_b32 v22, v3
    v_max_f32_dpp v18, v18, v18 quad_perm:[2,3,0,1] row_mask:0xf bank_mask:0xf
    s_nop 1
    v_max_f32_dpp v18, v18, v18 row_ror:4 row_mask:0xf bank_mask:0xf
    s_nop 1
    v_max_f32_dpp v18, v18, v18 row_ror:8 row_mask:0xf bank_mask:0xf
    v_mov_b32 v17, v18
    s_nop 1
    v_permlane16_swap_b32 v17, v18
    v_max_f32 v18, v18, v17
    v_mov_b32 v17, v18
    s_nop 1
    v_permlane32_swap_b32 v17, v18
    v_max_f32 v18, v18, v17
    v_mul_f32 v23, 0xbfb8aa3b, v18
    s_mov_b32 s37, 0x3fb8aa3b
    s_lshl_b32 s36, s3, 2
    v_lshl_add_u32 v16, v0, 4, s36
    s_mov_b32 exec_lo, 0x3
    s_mov_b32 exec_hi, 0x0
    ds_write_b32 v16, v23 offset:42496
    s_mov_b64 exec, -1
    v_mov_b32 v12, 0
    v_mov_b32 v13, 0
    v_mov_b32 v14, 0
    v_mov_b32 v15, 0
    s_and_b32 s40, s4, 7
    s_mul_i32 s56, s4, 7
    s_add_u32 s56, s56, s6
    s_cmp_gt_u32 s6, s40
    s_subb_u32 s56, s56, 0
    s_cmp_eq_u32 s6, s40
    s_cselect_b32 s57, 1, 0
    s_cmp_eq_u32 s5, 0
    s_cselect_b32 s57, 1, s57
    s_cselect_b32 s55, s6, 8
    s_lshl_b32 s39, s4, 1
    s_lshr_b32 s40, s3, 2
    s_add_u32 s39, s39, s40
    s_lshl_b32 s39, s39, 1
    s_and_b32 s40, s3, 1
    s_add_u32 s39, s39, s40
    s_lshl_b32 s39, s39, 5
    s_and_b32 s40, s3, 2
    s_add_u32 s39, s39, s40
    s_mul_i32 s39, s39, 2304
    s_lshl_b32 s40, s55, 7
    s_add_u32 s39, s39, s40
    s_add_u32 s44, s16, s39
    s_addc_u32 s45, s17, 0
    v_lshrrev_b32 v170, 3, v0
    v_mul_u32_u24 v170, 9216, v170
    v_and_b32 v171, 7, v0
    v_lshl_add_u32 v170, v171, 4, v170
    s_mov_b32 s36, 32
L_vloop:
    s_waitcnt lgkmcnt(0)
    v_fma_f32 v16, v22, s37, v23
    ds_read_b32 v22, v3 offset:256
    v_add_u32 v3, 0x100, v3
    v_exp_f32 v16, v16
    s_nop 0
    v_cvt_pk_bf16_f32 v20, v16, v16
    s_nop 1
    v_mov_b32_dpp v17, v20 row_newbcast:0 row_mask:0xf bank_mask:0x3
    s_nop 1
    v_mov_b32_dpp v17, v20 row_newbcast:1 row_mask:0xf bank_mask:0xc
    v_and_b32 v24, v17, v4
    v_and_b32 v25, v17, v5
    v_and_b32 v26, v17, v6
    v_and_b32 v27, v17, v7
    v_mov_b32 v102, s36
    ds_write_b32 v21, v102 offset:43584
    ds_read_b32 v100, v101 offset:44608
    s_cmp_le_u32 s58, 2
    s_cbranch_vccnz L_w57
    s_cbranch_scc0 L_x57
    s_waitcnt vmcnt(4)
L_x57:
    s_waitcnt vmcnt(5)
L_w57:
    s_waitcnt vmcnt(6)
    global_load_dwordx4 v[92:95], v2, s[32:33] offset:3072 nt
    v_mfma_f32_16x16x32_bf16 v[12:15], v[24:27], v[64:67], v[12:15]
    v_mov_b32_dpp v17, v20 row_newbcast:8 row_mask:0xf bank_mask:0x3
    s_nop 1
    v_mov_b32_dpp v17, v20 row_newbcast:9 row_mask:0xf bank_mask:0xc
    v_and_b32 v24, v17, v4
    v_and_b32 v25, v17, v5
    v_and_b32 v26, v17, v6
    v_and_b32 v27, v17, v7
    s_add_u32 s32, s32, 0x8000
    s_addc_u32 s33, s33, 0
    s_cmp_le_u32 s58, 2
    s_cbranch_vccnz L_w58
    s_cbranch_scc0 L_x58
    s_waitcnt vmcnt(4)
L_x58:
    s_waitcnt vmcnt(5)
L_w58:
    s_waitcnt vmcnt(6)
    global_load_dwordx4 v[64:67], v2, s[32:33] offset:-4096 nt
    v_mfma_f32_16x16x32_bf16 v[12:15], v[24:27], v[68:71], v[12:15]
    v_mov_b32_dpp v17, v20 row_newbcast:2 row_mask:0xf bank_mask:0x3
    s_nop 1
    v_mov_b32_dpp v17, v20 row_newbcast:3 row_mask:0xf bank_mask:0xc
    v_and_b32 v24, v17, v4
    v_and_b32 v25, v17, v5
    v_and_b32 v26, v17, v6
    v_and_b32 v27, v17, v7
    s_cbranch_vccnz L_w59
    s_cbranch_scc0 L_x59
    s_waitcnt vmcnt(4)
L_x59:
    s_waitcnt vmcnt(5)
L_w59:
    s_waitcnt vmcnt(6)
    global_load_dwordx4 v[68:71], v2, s[32:33] offset:-3072 nt
    v_mfma_f32_16x16x32_bf16 v[12:15], v[24:27], v[72:75], v[12:15]
    v_mov_b32_dpp v17, v20 row_newbcast:10 row_mask:0xf bank_mask:0x3
    s_nop 1
    v_mov_b32_dpp v17, v20 row_newbcast:11 row_mask:0xf bank_mask:0xc
    v_and_b32 v24, v17, v4
    v_and_b32 v25, v17, v5
    v_and_b32 v26, v17, v6
    v_and_b32 v27, v17, v7
    s_cbranch_vccnz L_w60
    s_cbranch_scc0 L_x60
    s_waitcnt vmcnt(4)
L_x60:
    s_waitcnt vmcnt(5)
L_w60:
    s_waitcnt vmcnt(6)
    global_load_dwordx4 v[72:75], v2, s[32:33] offset:-2048 nt
    v_mfma_f32_16x16x32_bf16 v[12:15], v[24:27], v[76:79], v[12:15]
    v_mov_b32_dpp v17, v20 row_newbcast:4 row_mask:0xf bank_mask:0x3
    s_nop 1
    v_mov_b32_dpp v17, v20 row_newbcast:5 row_mask:0xf bank_mask:0xc
    v_and_b32 v24, v17, v4
    v_and_b32 v25, v17, v5
    v_and_b32 v26, v17, v6
    v_and_b32 v27, v17, v7
    s_waitcnt lgkmcnt(0)
    v_cmp_le_u32 vcc, 6, v100
    v_readfirstlane_b32 s58, v100
    s_cmp_le_u32 s58, 2
    s_cbranch_vccnz L_w61
    s_cbranch_scc0 L_x61
    s_waitcnt vmcnt(4)
L_x61:
    s_waitcnt vmcnt(5)
L_w61:
    s_waitcnt vmcnt(6)
    global_load_dwordx4 v[76:79], v2, s[32:33] offset:-1024 nt
    v_mfma_f32_16x16x32_bf16 v[12:15], v[24:27], v[80:83], v[12:15]
    v_mov_b32_dpp v17, v20 row_newbcast:12 row_mask:0xf bank_mask:0x3
    s_nop 1
    v_mov_b32_dpp v17, v20 row_newbcast:13 row_mask:0xf bank_mask:0xc
    v_and_b32 v24, v17, v4
    v_and_b32 v25, v17, v5
    v_and_b32 v26, v17, v6
    v_and_b32 v27, v17, v7
    s_cbranch_vccnz L_w62
    s_cbranch_scc0 L_x62
    s_waitcnt vmcnt(4)
L_x62:
    s_waitcnt vmcnt(5)
L_w62:
    s_waitcnt vmcnt(6)
    global_load_dwordx4 v[80:83], v2, s[32:33] offset:0 nt
    v_mfma_f32_16x16x32_bf16 v[12:15], v[24:27], v[84:87], v[12:15]
    v_mov_b32_dpp v17, v20 row_newbcast:6 row_mask:0xf bank_mask:0x3
    s_nop 1
    v_mov_b32_dpp v17, v20 row_newbcast:7 row_mask:0xf bank_mask:0xc
    v_and_b32 v24, v17, v4
    v_and_b32 v25, v17, v5
    v_and_b32 v26, v17, v6
    v_and_b32 v27, v17, v7
    s_cbranch_vccnz L_w63
    s_cbranch_scc0 L_x63
    s_waitcnt vmcnt(4)
L_x63:
    s_waitcnt vmcnt(5)
L_w63:
    s_waitcnt vmcnt(6)
    global_load_dwordx4 v[84:87], v2, s[32:33] offset:1024 nt
    v_mfma_f32_16x16x32_bf16 v[12:15], v[24:27], v[88:91], v[12:15]
    v_mov_b32_dpp v17, v20 row_newbcast:14 row_mask:0xf bank_mask:0x3
    s_nop 1
    v_mov_b32_dpp v17, v20 row_newbcast:15 row_mask:0xf bank_mask:0xc
    v_and_b32 v24, v17, v4
    v_and_b32 v25, v17, v5
    v_and_b32 v26, v17, v6
    v_and_b32 v27, v17, v7
    s_cbranch_vccnz L_w64
    s_cbranch_scc0 L_x64
    s_waitcnt vmcnt(4)
L_x64:
    s_waitcnt vmcnt(5)
L_w64:
    s_waitcnt vmcnt(6)
    global_load_dwordx4 v[88:91], v2, s[32:33] offset:2048 nt
    v_mfma_f32_16x16x32_bf16 v[12:15], v[24:27], v[92:95], v[12:15]
    s_add_u32 s36, s36, 1
    s_cmp_lg_u32 s36, 63
    s_cbranch_scc1 L_vloop
    v_mov_b32 v102, s36
    ds_write_b32 v21, v102 offset:43584
    s_waitcnt lgkmcnt(0)
    v_fma_f32 v16, v22, s37, v23
    v_exp_f32 v16, v16
    s_nop 0
    v_cvt_pk_bf16_f32 v20, v16, v16
    s_nop 1
    v_mov_b32_dpp v17, v20 row_newbcast:0 row_mask:0xf bank_mask:0x3
    s_nop 1
    v_mov_b32_dpp v17, v20 row_newbcast:1 row_mask:0xf bank_mask:0xc
    v_and_b32 v24, v17, v4
    v_and_b32 v25, v17, v5
    v_and_b32 v26, v17, v6
    v_and_b32 v27, v17, v7
    s_waitcnt vmcnt(6)
    global_load_dwordx4 v[92:95], v2, s[32:33] offset:3072 nt
    v_mfma_f32_16x16x32_bf16 v[12:15], v[24:27], v[64:67], v[12:15]
    v_mov_b32_dpp v17, v20 row_newbcast:8 row_mask:0xf bank_mask:0x3
    s_nop 1
    v_mov_b32_dpp v17, v20 row_newbcast:9 row_mask:0xf bank_mask:0xc
    v_and_b32 v24, v17, v4
    v_and_b32 v25, v17, v5
    v_and_b32 v26, v17, v6
    v_and_b32 v27, v17, v7
    s_waitcnt vmcnt(6)
    s_nop 0
    v_mfma_f32_16x16x32_bf16 v[12:15], v[24:27], v[68:71], v[12:15]
    s_lshl_b32 s36, s3, 10
    v_add_u32 v3, s36, v2
    v_mov_b32_dpp v17, v20 row_newbcast:2 row_mask:0xf bank_mask:0x3
    s_nop 1
    v_mov_b32_dpp v17, v20 row_newbcast:3 row_mask:0xf bank_mask:0xc
    v_and_b32 v24, v17, v4
    v_and_b32 v25, v17, v5
    v_and_b32 v26, v17, v6
    v_and_b32 v27, v17, v7
    s_waitcnt vmcnt(5)
    s_nop 0
    v_mfma_f32_16x16x32_bf16 v[12:15], v[24:27], v[72:75], v[12:15]
    v_mov_b32_dpp v17, v20 row_newbcast:10 row_mask:0xf bank_mask:0x3
    s_nop 1
    v_mov_b32_dpp v17, v20 row_newbcast:11 row_mask:0xf bank_mask:0xc
    v_and_b32 v24, v17, v4
    v_and_b32 v25, v17, v5
    v_and_b32 v26, v17, v6
    v_and_b32 v27, v17, v7
    s_waitcnt vmcnt(4)
    s_nop 0
    v_mfma_f32_16x16x32_bf16 v[12:15], v[24:27], v[76:79], v[12:15]
    v_mov_b32_dpp v17, v20 row_newbcast:4 row_mask:0xf bank_mask:0x3
    s_nop 1
    v_mov_b32_dpp v17, v20 row_newbcast:5 row_mask:0xf bank_mask:0xc
    v_and_b32 v24, v17, v4
    v_and_b32 v25, v17, v5
    v_and_b32 v26, v17, v6
    v_and_b32 v27, v17, v7
    s_waitcnt vmcnt(3)
    s_nop 0
    v_mfma_f32_16x16x32_bf16 v[12:15], v[24:27], v[80:83], v[12:15]
    v_mov_b32_dpp v17, v20 row_newbcast:12 row_mask:0xf bank_mask:0x3
    s_nop 1
    v_mov_b32_dpp v17, v20 row_newbcast:13 row_mask:0xf bank_mask:0xc
    v_and_b32 v24, v17, v4
    v_and_b32 v25, v17, v5
    v_and_b32 v26, v17, v6
    v_and_b32 v27, v17, v7
    s_waitcnt vmcnt(2)
    s_nop 0
    v_mfma_f32_16x16x32_bf16 v[12:15], v[24:27], v[84:87], v[12:15]
    v_mov_b32_dpp v17, v20 row_newbcast:6 row_mask:0xf bank_mask:0x3
    s_nop 1
    v_mov_b32_dpp v17, v20 row_newbcast:7 row_mask:0xf bank_mask:0xc
    v_and_b32 v24, v17, v4
    v_and_b32 v25, v17, v5
    v_and_b32 v26, v17, v6
    v_and_b32 v27, v17, v7
    s_waitcnt vmcnt(1)
    s_nop 0
    v_mfma_f32_16x16x32_bf16 v[12:15], v[24:27], v[88:91], v[12:15]
    v_mov_b32_dpp v17, v20 row_newbcast:14 row_mask:0xf bank_mask:0x3
    s_nop 1
    v_mov_b32_dpp v17, v20 row_newbcast:15 row_mask:0xf bank_mask:0xc
    v_and_b32 v24, v17, v4
    v_and_b32 v25, v17, v5
    v_and_b32 v26, v17, v6
    v_and_b32 v27, v17, v7
    s_waitcnt vmcnt(0)
    s_nop 0
    v_mfma_f32_16x16x32_bf16 v[12:15], v[24:27], v[92:95], v[12:15]
    v_mov_b32 v102, 64
    ds_write_b32 v21, v102 offset:43584
    s_nop 5
    ds_write_b128 v3, v[12:15] offset:38400
    s_cmp_eq_u32 s57, 0
    s_cbranch_scc1 L_fin
    global_load_dwordx4 v[112:115], v170, s[44:45] offset:0 nt
    global_load_dwordx4 v[116:119], v170, s[44:45] offset:1152 nt
    global_load_dwordx4 v[120:123], v170, s[44:45] offset:2304 nt
    global_load_dwordx4 v[124:127], v170, s[44:45] offset:3456 nt
    s_waitcnt lgkmcnt(0)
L_b2:
    s_barrier
    s_lshl_b32 s40, s55, 13
    s_lshl_b32 s41, s4, 7
    s_add_u32 s40, s40, s41
    s_add_u32 s40, s40, 1703936
    v_lshrrev_b32 v30, 5, v0
    v_bfe_u32 v31, v0, 2, 1
    v_lshl_or_b32 v30, v30, 1, v31
    v_mul_u32_u24 v240, 2048, v30
    v_and_b32 v30, 16, v0
    v_lshl_or_b32 v240, v30, 2, v240
    v_and_b32 v30, 3, v0
    v_lshl_or_b32 v240, v30, 4, v240
    v_add_u32 v240, s40, v240
    s_lshl_b32 s40, s4, 13
    s_lshl_b32 s41, s3, 7
    s_add_u32 s40, s40, s41
    s_add_u32 s40, s40, 1048576
    v_lshrrev_b32 v30, 3, v0
    v_and_b32 v31, 7, v0
    v_lshlrev_b32 v31, 4, v31
    v_lshl_or_b32 v243, v30, 10, v31
    v_add_u32 v243, s40, v243
    v_add_u32 v244, 0x20000, v243
    s_lshl_b32 s40, s3, 8
    v_and_or_b32 v30, v0, 8, v30
    v_lshl_add_u32 v80, v30, 4, s40
    v_xor_b32 v81, 16, v80
    v_lshrrev_b32 v30, 5, v0
    v_lshl_or_b32 v31, v30, 7, v31
    v_bfe_u32 v30, v0, 4, 1
    v_lshl_or_b32 v31, v30, 3, v31
    v_add_u32 v250, s40, v31
    s_lshl_b32 s40, s3, 10
    v_lshl_add_u32 v245, v0, 4, s40
    v_mov_b32 v84, 0xff
    v_mov_b32 v31, 0
    s_mov_b32 s42, 131072
L_fw:
    ds_read_b32 v30, v31 offset:44636
    s_sub_u32 s42, s42, 1
    s_cbranch_scc1 L_fwx
    s_waitcnt lgkmcnt(0)
    v_cmp_eq_u32 vcc, 0, v30
    s_cbranch_vccnz L_fw
L_fwx:
    s_waitcnt lgkmcnt(0)
L_poll:
    s_mov_b32 s42, 131072
L_g1:
    global_load_dwordx4 v[160:163], v243, s[30:31] sc1
    global_load_dwordx4 v[164:167], v244, s[30:31] sc1
    s_sub_u32 s42, s42, 1
    s_waitcnt vmcnt(0)
    s_cbranch_scc1 L_g1x
    v_xor_b32 v160, s76, v160
    v_xor_b32 v161, s77, v161
    v_xor_b32 v162, s78, v162
    v_xor_b32 v163, s79, v163
    v_xor_b32 v164, s76, v164
    v_xor_b32 v165, s77, v165
    v_xor_b32 v166, s78, v166
    v_xor_b32 v167, s79, v167
    v_or3_b32 v30, v160, v161, v162
    v_or3_b32 v30, v30, v163, v164
    v_or3_b32 v30, v30, v165, v166
    v_or_b32 v30, v30, v167
    v_and_b32 v30, 255, v30
    v_cmp_ne_u32 vcc, 0, v30
    s_mov_b64 exec, vcc
    s_cbranch_vccnz L_g1
L_g1x:
    s_mov_b64 exec, -1
    v_permlane32_swap_b32 v160, v164
    v_permlane32_swap_b32 v161, v165
    v_permlane32_swap_b32 v162, v166
    v_permlane32_swap_b32 v163, v167
    v_pk_add_f32 v[160:161], v[160:161], v[164:165]
    v_pk_add_f32 v[162:163], v[162:163], v[166:167]
    s_nop 1
    v_permlane16_swap_b32 v160, v162
    v_permlane16_swap_b32 v161, v163
    v_pk_add_f32 v[160:161], v[160:161], v[162:163]
    s_nop 1
    v_add_f32_dpp v160, v160, v160 row_ror:8 row_mask:0xf bank_mask:0xf
    v_add_f32_dpp v161, v161, v161 row_ror:8 row_mask:0xf bank_mask:0xf
    v_cvt_pk_bf16_f32 v160, v160, v160
    v_cvt_pk_bf16_f32 v161, v161, v161
    ds_write_b64 v250, v[160:161] offset:16384
    ds_read_b128 v[48:51], v80 offset:16384
    ds_read_b128 v[52:55], v81 offset:16384
    s_waitcnt lgkmcnt(0)
    v_and_b32 v128, v48, v4
    v_and_b32 v129, v48, v5
    v_and_b32 v130, v48, v6
    v_and_b32 v131, v48, v7
    v_and_b32 v132, v52, v4
    v_and_b32 v133, v52, v5
    v_and_b32 v134, v52, v6
    v_and_b32 v135, v52, v7
    v_mfma_f32_16x16x32_bf16 v[56:59], v[128:131], v[112:115], 0
    v_and_b32 v136, v49, v4
    v_and_b32 v137, v49, v5
    v_and_b32 v138, v49, v6
    v_and_b32 v139, v49, v7
    v_mfma_f32_16x16x32_bf16 v[60:63], v[132:135], v[112:115], 0
    v_and_b32 v140, v53, v4
    v_and_b32 v141, v53, v5
    v_and_b32 v142, v53, v6
    v_and_b32 v143, v53, v7
    v_mfma_f32_16x16x32_bf16 v[56:59], v[136:139], v[116:119], v[56:59]
    v_and_b32 v144, v50, v4
    v_and_b32 v145, v50, v5
    v_and_b32 v146, v50, v6
    v_and_b32 v147, v50, v7
    v_mfma_f32_16x16x32_bf16 v[60:63], v[140:143], v[116:119], v[60:63]
    v_and_b32 v148, v54, v4
    v_and_b32 v149, v54, v5
    v_and_b32 v150, v54, v6
    v_and_b32 v151, v54, v7
    v_mfma_f32_16x16x32_bf16 v[56:59], v[144:147], v[120:123], v[56:59]
    v_and_b32 v152, v51, v4
    v_and_b32 v153, v51, v5
    v_and_b32 v154, v51, v6
    v_and_b32 v155, v51, v7
    v_mfma_f32_16x16x32_bf16 v[60:63], v[148:151], v[120:123], v[60:63]
    v_and_b32 v156, v55, v4
    v_and_b32 v157, v55, v5
    v_and_b32 v158, v55, v6
    v_and_b32 v159, v55, v7
    v_mfma_f32_16x16x32_bf16 v[56:59], v[152:155], v[124:127], v[56:59]
    s_nop 0
    v_mfma_f32_16x16x32_bf16 v[60:63], v[156:159], v[124:127], v[60:63]
    s_nop 7
    v_add_f32_dpp v252, v60, v56 row_ror:8 row_mask:0xf bank_mask:0xf
    v_add_f32_dpp v253, v61, v57 row_ror:8 row_mask:0xf bank_mask:0xf
    v_add_f32_dpp v254, v62, v58 row_ror:8 row_mask:0xf bank_mask:0xf
    v_add_f32_dpp v255, v63, v59 row_ror:8 row_mask:0xf bank_mask:0xf
    s_mov_b32 exec_lo, 0xff00ff
    s_mov_b32 exec_hi, 0xff00ff00
    ds_write_b128 v245, v[252:255] offset:0
    s_cmp_lg_u32 s3, 0
    s_waitcnt lgkmcnt(0)
    s_barrier
    s_cbranch_scc1 L_sd
    ds_read_b128 v[100:103], v245 offset:1024
    ds_read_b128 v[104:107], v245 offset:2048
    ds_read_b128 v[108:111], v245 offset:3072
    ds_read_b128 v[112:115], v245 offset:4096
    ds_read_b128 v[116:119], v245 offset:5120
    ds_read_b128 v[120:123], v245 offset:6144
    ds_read_b128 v[124:127], v245 offset:7168
    s_waitcnt lgkmcnt(6)
    v_pk_add_f32 v[252:253], v[252:253], v[100:101]
    v_pk_add_f32 v[254:255], v[254:255], v[102:103]
    s_waitcnt lgkmcnt(5)
    v_pk_add_f32 v[252:253], v[252:253], v[104:105]
    v_pk_add_f32 v[254:255], v[254:255], v[106:107]
    s_waitcnt lgkmcnt(4)
    v_pk_add_f32 v[252:253], v[252:253], v[108:109]
    v_pk_add_f32 v[254:255], v[254:255], v[110:111]
    s_waitcnt lgkmcnt(3)
    v_pk_add_f32 v[252:253], v[252:253], v[112:113]
    v_pk_add_f32 v[254:255], v[254:255], v[114:115]
    s_waitcnt lgkmcnt(2)
    v_pk_add_f32 v[252:253], v[252:253], v[116:117]
    v_pk_add_f32 v[254:255], v[254:255], v[118:119]
    s_waitcnt lgkmcnt(1)
    v_pk_add_f32 v[252:253], v[252:253], v[120:121]
    v_pk_add_f32 v[254:255], v[254:255], v[122:123]
    s_waitcnt lgkmcnt(0)
    v_pk_add_f32 v[252:253], v[252:253], v[124:125]
    v_pk_add_f32 v[254:255], v[254:255], v[126:127]
    v_bfi_b32 v252, v84, s76, v252
    v_bfi_b32 v253, v84, s77, v253
    v_bfi_b32 v254, v84, s78, v254
    v_bfi_b32 v255, v84, s79, v255
    global_store_dwordx4 v240, v[252:255], s[30:31] sc1
L_sd:
    s_endpgm
L_fin:
    s_waitcnt lgkmcnt(0)
    s_barrier
    s_sub_u32 s56, s56, 76
    s_cbranch_scc1 L_sd
    s_cmp_gt_u32 s3, 1
    s_cbranch_scc1 L_sd
    v_lshlrev_b32 v245, 2, v0
    s_cmp_eq_u32 s3, 0
    s_cbranch_scc1 L_f0
    s_mul_i32 s40, s56, 1536
    s_add_u32 s40, s40, 1507328
    v_add_u32 v80, s40, v2
    v_mov_b32 v31, 0
    s_mov_b32 s42, 131072
L_o1:
    ds_read_b32 v30, v31 offset:44636
    s_sub_u32 s42, s42, 1
    s_cbranch_scc1 L_o1x
    s_waitcnt lgkmcnt(0)
    v_cmp_eq_u32 vcc, 0, v30
    s_cbranch_vccnz L_o1
L_o1x:
    s_waitcnt lgkmcnt(0)
    s_cmp_ge_u32 s56, 32
    s_cbranch_scc1 L_o1bx
    v_mov_b32 v31, 0
    s_mov_b32 s42, 131072
L_o1b:
    ds_read_b32 v30, v31 offset:44628
    s_sub_u32 s42, s42, 1
    s_cbranch_scc1 L_o1bx
    s_waitcnt lgkmcnt(0)
    v_cmp_eq_u32 vcc, 0, v30
    s_cbranch_vccnz L_o1b
L_o1bx:
    s_waitcnt lgkmcnt(0)
    s_mov_b32 s42, 131072
L_fl:
    global_load_dwordx4 v[96:99], v80, s[30:31] offset:0 sc1
    global_load_dwordx4 v[100:103], v80, s[30:31] offset:512 sc1
    s_sub_u32 s42, s42, 1
    s_waitcnt vmcnt(0)
    s_cbranch_scc1 L_flx
    v_xor_b32 v96, s76, v96
    v_xor_b32 v97, s77, v97
    v_xor_b32 v98, s78, v98
    v_xor_b32 v99, s79, v99
    v_xor_b32 v100, s76, v100
    v_xor_b32 v101, s77, v101
    v_xor_b32 v102, s78, v102
    v_xor_b32 v103, s79, v103
    v_or3_b32 v30, v96, v97, v98
    v_or3_b32 v30, v30, v99, v100
    v_or3_b32 v30, v30, v101, v102
    v_or_b32 v30, v30, v103
    v_and_b32 v30, 255, v30
    v_cmp_ne_u32 vcc, 0, v30
    s_mov_b64 exec, vcc
    s_cbranch_vccnz L_fl
L_flx:
    s_mov_b64 exec, -1
    s_mov_b32 exec_lo, 0
    v_pk_add_f32 v[96:97], v[96:97], v[100:101]
    v_pk_add_f32 v[98:99], v[98:99], v[102:103]
    s_mov_b64 exec, -1
    v_permlane32_swap_b32 v96, v97
    v_permlane32_swap_b32 v98, v99
    v_add_f32 v96, v96, v97
    v_add_f32 v98, v98, v99
    s_nop 1
    v_permlane16_swap_b32 v96, v98
    v_add_f32 v96, v96, v98
    s_nop 1
    v_add_f32_dpp v96, v96, v96 row_ror:8 row_mask:0xf bank_mask:0xf
    v_cvt_pk_bf16_f32 v96, v96, v96
    v_and_b32 v96, 0xffff0000, v96
    v_mul_f32 v241, 0xbfb8aa3b, v96
    v_exp_f32 v241, v241
    s_nop 0
    v_add_f32 v241, 1.0, v241
    v_rcp_f32 v241, v241
    s_nop 0
    v_mul_f32 v241, v241, v96
    v_cvt_pk_bf16_f32 v241, v241, v241
    v_and_b32 v241, 0xffff0000, v241
    v_or_b32 v241, 1, v241
    ds_write_b32 v245, v241 offset:44672
    s_waitcnt lgkmcnt(0)
    s_branch L_sd
L_f0:
    s_lshr_b32 s40, s56, 2
    s_lshl_b32 s40, s40, 7
    s_bfe_u32 s41, s56, 0x10001
    s_mul_i32 s41, s41, 1152
    s_add_u32 s40, s40, s41
    s_and_b32 s41, s56, 1
    s_lshl_b32 s41, s41, 6
    s_add_u32 s40, s40, s41
    v_bfe_u32 v32, v0, 4, 1
    v_lshrrev_b32 v30, 5, v0
    v_lshl_or_b32 v32, v32, 1, v30
    v_and_b32 v30, 4, v0
    v_or_b32 v32, v32, v30
    v_and_b32 v30, 3, v0
    v_lshl_or_b32 v32, v30, 3, v32
    v_lshl_add_u32 v248, v32, 1, s40
    s_lshl_b32 s40, s56, 11
    s_add_u32 s40, s40, 1703936
    v_add_u32 v80, s40, v2
    v_mov_b32 v31, 0
    s_mov_b32 s42, 131072
L_o0:
    ds_read_b32 v30, v31 offset:44636
    s_sub_u32 s42, s42, 1
    s_cbranch_scc1 L_o0x
    s_waitcnt lgkmcnt(0)
    v_cmp_eq_u32 vcc, 0, v30
    s_cbranch_vccnz L_o0
L_o0x:
    s_waitcnt lgkmcnt(0)
    s_cmp_ge_u32 s56, 32
    s_cbranch_scc1 L_o0bx
    v_mov_b32 v31, 0
    s_mov_b32 s42, 131072
L_o0b:
    ds_read_b32 v30, v31 offset:44628
    s_sub_u32 s42, s42, 1
    s_cbranch_scc1 L_o0bx
    s_waitcnt lgkmcnt(0)
    v_cmp_eq_u32 vcc, 0, v30
    s_cbranch_vccnz L_o0b
L_o0bx:
    s_waitcnt lgkmcnt(0)
    s_mov_b32 s42, 131072
    global_load_ushort v242, v248, s[8:9]
L_g2:
    global_load_dwordx4 v[96:99], v80, s[30:31] offset:0 sc1
    global_load_dwordx4 v[100:103], v80, s[30:31] offset:1024 sc1
    s_sub_u32 s42, s42, 1
    s_waitcnt vmcnt(0)
    s_cbranch_scc1 L_g2x
    v_xor_b32 v96, s76, v96
    v_xor_b32 v97, s77, v97
    v_xor_b32 v98, s78, v98
    v_xor_b32 v99, s79, v99
    v_xor_b32 v100, s76, v100
    v_xor_b32 v101, s77, v101
    v_xor_b32 v102, s78, v102
    v_xor_b32 v103, s79, v103
    v_or3_b32 v30, v96, v97, v98
    v_or3_b32 v30, v30, v99, v100
    v_or3_b32 v30, v30, v101, v102
    v_or_b32 v30, v30, v103
    v_and_b32 v30, 255, v30
    v_cmp_ne_u32 vcc, 0, v30
    s_mov_b64 exec, vcc
    s_cbranch_vccnz L_g2
L_g2x:
    s_mov_b64 exec, -1
    ds_read_b32 v241, v245 offset:44672
    v_pk_add_f32 v[96:97], v[96:97], v[100:101]
    v_pk_add_f32 v[98:99], v[98:99], v[102:103]
    s_nop 0
    v_permlane32_swap_b32 v96, v97
    v_permlane32_swap_b32 v98, v99
    v_add_f32 v96, v96, v97
    v_add_f32 v98, v98, v99
    s_nop 1
    v_permlane16_swap_b32 v96, v98
    v_add_f32 v96, v96, v98
    s_nop 1
    v_add_f32_dpp v96, v96, v96 row_ror:8 row_mask:0xf bank_mask:0xf
    v_cvt_pk_bf16_f32 v96, v96, v96
    v_and_b32 v96, 0xffff0000, v96
    v_lshlrev_b32 v242, 16, v242
    s_mov_b32 s42, 131072
L_gw:
    s_waitcnt lgkmcnt(0)
    v_cmp_eq_u32 vcc, 0, v241
    s_cbranch_vccz L_gx
    ds_read_b32 v241, v245 offset:44672
    s_sub_u32 s42, s42, 1
    s_cbranch_scc0 L_gw
    s_waitcnt lgkmcnt(0)
L_gx:
    v_and_b32 v241, 0xffff0000, v241
    v_mul_f32 v96, v96, v241
    v_cvt_pk_bf16_f32 v96, v96, v96
    v_and_b32 v96, 0xffff0000, v96
    v_add_f32 v96, v96, v242
    v_cvt_pk_bf16_f32 v96, v96, v96
    s_mov_b32 exec_lo, 0xff00ff
    s_mov_b32 exec_hi, 0xff00ff
    global_store_short v248, v96, s[26:27]
    s_cmp_lg_u32 s56, 0
    s_cbranch_scc1 L_fe
    s_add_u32 s53, s53, 1
    s_mov_b32 exec_lo, 0x1
    s_mov_b32 exec_hi, 0x0
    v_mov_b32 v30, s53
    v_mov_b32 v31, 1048320
    global_store_dword v31, v30, s[30:31] sc1
L_fe:
    s_endpgm
L_gqs:
    s_mov_b32 s42, 131072
L_gq:
    global_load_dwordx4 v[8:11], v24, s[30:31] sc1
    s_sub_u32 s42, s42, 1
    s_waitcnt vmcnt(0)
    s_cbranch_scc1 L_gqok
    v_xor_b32 v8, s80, v8
    v_xor_b32 v9, s80, v9
    v_xor_b32 v10, s80, v10
    v_xor_b32 v11, s80, v11
    v_or3_b32 v17, v8, v9, v10
    v_or_b32 v17, v17, v11
    v_and_b32 v17, 65535, v17
    v_cmp_ne_u32 vcc, 0, v17
    s_cbranch_vccnz L_gq
    s_branch L_gqok
L_helper:
    s_sub_u32 s38, s3, 4
    v_mov_b32 v248, 0
    v_lshrrev_b32 v81, 3, v0
    v_and_b32 v83, 7, v0
    v_lshlrev_b32 v83, 4, v83
    s_cmp_ge_u32 s2, 192
    s_cselect_b32 s52, 0, s38
    s_cmp_lg_u32 s52, 0
    s_cbranch_scc1 L_hother
    v_mul_u32_u24 v1, 36, v0
    v_mul_u32_u24 v82, 18, v81
    v_lshl_or_b32 v80, v82, 13, v83
    s_sub_u32 s51, s2, 192
    s_mul_i32 s39, s38, 1179648
    s_lshl_b32 s40, s51, 7
    s_add_u32 s39, s39, s40
    s_waitcnt lgkmcnt(0)
    global_load_dwordx4 v[2:5], v1, s[8:9]
    global_load_dwordx4 v[6:9], v1, s[8:9] offset:16
    global_load_dword v10, v1, s[8:9] offset:32
    s_load_dword s53, s[30:31], 1048320
    s_cmp_lt_u32 s2, 192
    s_cbranch_scc1 L_nq
    s_add_u32 s44, s14, s39
    s_addc_u32 s45, s15, 0
    global_load_dwordx4 v[96:99], v80, s[44:45] nt
    v_add_u32 v80, 0x2000, v80
    global_load_dwordx4 v[100:103], v80, s[44:45] nt
    v_add_u32 v80, 0x2000, v80
    global_load_dwordx4 v[104:107], v80, s[44:45] nt
    v_add_u32 v80, 0x2000, v80
    global_load_dwordx4 v[108:111], v80, s[44:45] nt
    v_add_u32 v80, 0x2000, v80
    global_load_dwordx4 v[112:115], v80, s[44:45] nt
    v_add_u32 v80, 0x2000, v80
    global_load_dwordx4 v[116:119], v80, s[44:45] nt
    v_add_u32 v80, 0x2000, v80
    global_load_dwordx4 v[120:123], v80, s[44:45] nt
    v_add_u32 v80, 0x2000, v80
    global_load_dwordx4 v[124:127], v80, s[44:45] nt
    v_add_u32 v80, 0x2000, v80
    global_load_dwordx4 v[128:131], v80, s[44:45] nt
    v_add_u32 v80, 0x2000, v80
    global_load_dwordx4 v[132:135], v80, s[44:45] nt
    v_add_u32 v80, 0x2000, v80
    global_load_dwordx4 v[136:139], v80, s[44:45] nt
    v_add_u32 v80, 0x2000, v80
    global_load_dwordx4 v[140:143], v80, s[44:45] nt
    v_add_u32 v80, 0x2000, v80
    global_load_dwordx4 v[144:147], v80, s[44:45] nt
    v_add_u32 v80, 0x2000, v80
    global_load_dwordx4 v[148:151], v80, s[44:45] nt
    v_add_u32 v80, 0x2000, v80
    global_load_dwordx4 v[152:155], v80, s[44:45] nt
    v_add_u32 v80, 0x2000, v80
    global_load_dwordx4 v[156:159], v80, s[44:45] nt
    v_add_u32 v80, 0x2000, v80
    global_load_dwordx4 v[160:163], v80, s[44:45] nt
    v_add_u32 v80, 0x2000, v80
    global_load_dwordx4 v[164:167], v80, s[44:45] nt
L_nq:
    s_barrier
    v_mov_b32 v31, 0xffff
    v_and_b32 v30, 1, v0
    v_lshlrev_b32 v30, 4, v30
    v_lshlrev_b32 v30, v30, v31
    v_bfe_u32 v31, v0, 1, 2
    v_cmp_eq_u32 vcc, 0, v31
    s_nop 1
    v_cndmask_b32 v36, 0, v30, vcc
    v_cmp_eq_u32 vcc, 1, v31
    s_nop 1
    v_cndmask_b32 v37, 0, v30, vcc
    v_cmp_eq_u32 vcc, 2, v31
    s_nop 1
    v_cndmask_b32 v38, 0, v30, vcc
    v_cmp_eq_u32 vcc, 3, v31
    s_nop 1
    v_cndmask_b32 v39, 0, v30, vcc
    s_mul_i32 s40, s38, 576
    v_lshl_add_u32 v82, v82, 2, s40
    v_lshlrev_b32 v1, 1, v1
    v_mov_b32 v84, 0xff
    v_mov_b32 v56, 0
    v_mov_b32 v57, 0
    v_mov_b32 v58, 0
    v_mov_b32 v59, 0
    v_mov_b32 v60, 0
    v_mov_b32 v61, 0
    v_mov_b32 v62, 0
    v_mov_b32 v63, 0
    s_cmp_lt_u32 s2, 192
    s_cbranch_scc0 L_xq
    s_waitcnt vmcnt(0)
L_xq:
    s_waitcnt vmcnt(18)
    v_lshlrev_b32 v12, 16, v2
    v_and_b32 v13, 0xffff0000, v2
    v_lshlrev_b32 v14, 16, v3
    v_and_b32 v15, 0xffff0000, v3
    v_lshlrev_b32 v16, 16, v4
    v_and_b32 v17, 0xffff0000, v4
    v_lshlrev_b32 v18, 16, v5
    v_and_b32 v19, 0xffff0000, v5
    v_lshlrev_b32 v20, 16, v6
    v_and_b32 v21, 0xffff0000, v6
    v_lshlrev_b32 v22, 16, v7
    v_and_b32 v23, 0xffff0000, v7
    v_lshlrev_b32 v24, 16, v8
    v_and_b32 v25, 0xffff0000, v8
    v_lshlrev_b32 v26, 16, v9
    v_and_b32 v27, 0xffff0000, v9
    v_lshlrev_b32 v28, 16, v10
    v_and_b32 v29, 0xffff0000, v10
    v_pk_add_f32 v[30:31], v[12:13], v[14:15]
    v_pk_add_f32 v[30:31], v[30:31], v[16:17]
    v_pk_add_f32 v[30:31], v[30:31], v[18:19]
    v_pk_add_f32 v[30:31], v[30:31], v[20:21]
    v_pk_add_f32 v[30:31], v[30:31], v[22:23]
    v_pk_add_f32 v[30:31], v[30:31], v[24:25]
    v_pk_add_f32 v[30:31], v[30:31], v[26:27]
    v_pk_add_f32 v[30:31], v[30:31], v[28:29]
    v_add_f32 v30, v30, v31
    s_nop 1
    v_add_f32_dpp v30, v30, v30 quad_perm:[1,0,3,2] row_mask:0xf bank_mask:0xf
    s_nop 1
    v_add_f32_dpp v30, v30, v30 quad_perm:[2,3,0,1] row_mask:0xf bank_mask:0xf
    s_nop 1
    v_add_f32_dpp v30, v30, v30 row_ror:4 row_mask:0xf bank_mask:0xf
    s_nop 1
    v_add_f32_dpp v30, v30, v30 row_ror:8 row_mask:0xf bank_mask:0xf
    v_mov_b32 v31, v30
    s_nop 1
    v_permlane16_swap_b32 v31, v30
    v_add_f32 v30, v30, v31
    v_mul_f32 v30, 0x3ae38e39, v30
    v_mov_b32 v32, 0
    v_sub_f32 v31, v12, v30
    v_fmac_f32 v32, v31, v31
    v_sub_f32 v31, v13, v30
    v_fmac_f32 v32, v31, v31
    v_sub_f32 v31, v14, v30
    v_fmac_f32 v32, v31, v31
    v_sub_f32 v31, v15, v30
    v_fmac_f32 v32, v31, v31
    v_sub_f32 v31, v16, v30
    v_fmac_f32 v32, v31, v31
    v_sub_f32 v31, v17, v30
    v_fmac_f32 v32, v31, v31
    v_sub_f32 v31, v18, v30
    v_fmac_f32 v32, v31, v31
    v_sub_f32 v31, v19, v30
    v_fmac_f32 v32, v31, v31
    v_sub_f32 v31, v20, v30
    v_fmac_f32 v32, v31, v31
    v_sub_f32 v31, v21, v30
    v_fmac_f32 v32, v31, v31
    v_sub_f32 v31, v22, v30
    v_fmac_f32 v32, v31, v31
    v_sub_f32 v31, v23, v30
    v_fmac_f32 v32, v31, v31
    v_sub_f32 v31, v24, v30
    v_fmac_f32 v32, v31, v31
    v_sub_f32 v31, v25, v30
    v_fmac_f32 v32, v31, v31
    v_sub_f32 v31, v26, v30
    v_fmac_f32 v32, v31, v31
    v_sub_f32 v31, v27, v30
    v_fmac_f32 v32, v31, v31
    v_sub_f32 v31, v28, v30
    v_fmac_f32 v32, v31, v31
    v_sub_f32 v31, v29, v30
    v_fmac_f32 v32, v31, v31
    s_nop 1
    v_add_f32_dpp v32, v32, v32 quad_perm:[1,0,3,2] row_mask:0xf bank_mask:0xf
    s_nop 1
    v_add_f32_dpp v32, v32, v32 quad_perm:[2,3,0,1] row_mask:0xf bank_mask:0xf
    s_nop 1
    v_add_f32_dpp v32, v32, v32 row_ror:4 row_mask:0xf bank_mask:0xf
    s_nop 1
    v_add_f32_dpp v32, v32, v32 row_ror:8 row_mask:0xf bank_mask:0xf
    v_mov_b32 v31, v32
    s_nop 1
    v_permlane16_swap_b32 v31, v32
    v_add_f32 v32, v32, v31
    v_mul_f32 v32, 0x3ae38e39, v32
    v_cvt_pk_bf16_f32 v30, v30, v30
    v_and_b32 v30, 0xffff0000, v30
    v_cvt_pk_bf16_f32 v32, v32, v32
    v_and_b32 v32, 0xffff0000, v32
    v_add_f32 v32, 0x3727c5ac, v32
    v_cvt_pk_bf16_f32 v32, v32, v32
    v_and_b32 v32, 0xffff0000, v32
    v_sqrt_f32 v32, v32
    s_nop 0
    v_cvt_pk_bf16_f32 v32, v32, v32
    v_and_b32 v32, 0xffff0000, v32
    v_rcp_f32 v32, v32
    s_waitcnt lgkmcnt(0)
    s_mul_i32 s54, s53, 0x9e3779b1
    s_add_u32 s54, s54, 0x7f4a7c15
    s_and_b32 s76, s54, 0xff
    s_bfe_u32 s77, s54, 0x80008
    s_bfe_u32 s78, s54, 0x80010
    s_lshr_b32 s79, s54, 24
    s_and_b32 s80, s54, 0xffff
    v_sub_f32 v12, v12, v30
    v_sub_f32 v13, v13, v30
    v_cvt_pk_bf16_f32 v13, v12, v13
    v_lshlrev_b32 v12, 16, v13
    v_and_b32 v13, 0xffff0000, v13
    v_mul_f32 v12, v12, v32
    v_mul_f32 v13, v13, v32
    v_cvt_pk_bf16_f32 v12, v12, v12
    v_cvt_pk_bf16_f32 v13, v13, v13
    ds_write_b64 v1, v[12:13] offset:32768
    v_sub_f32 v14, v14, v30
    v_sub_f32 v15, v15, v30
    v_cvt_pk_bf16_f32 v15, v14, v15
    v_lshlrev_b32 v14, 16, v15
    v_and_b32 v15, 0xffff0000, v15
    v_mul_f32 v14, v14, v32
    v_mul_f32 v15, v15, v32
    v_cvt_pk_bf16_f32 v14, v14, v14
    v_cvt_pk_bf16_f32 v15, v15, v15
    ds_write_b64 v1, v[14:15] offset:32776
    v_sub_f32 v16, v16, v30
    v_sub_f32 v17, v17, v30
    v_cvt_pk_bf16_f32 v17, v16, v17
    v_lshlrev_b32 v16, 16, v17
    v_and_b32 v17, 0xffff0000, v17
    v_mul_f32 v16, v16, v32
    v_mul_f32 v17, v17, v32
    v_cvt_pk_bf16_f32 v16, v16, v16
    v_cvt_pk_bf16_f32 v17, v17, v17
    ds_write_b64 v1, v[16:17] offset:32784
    v_sub_f32 v18, v18, v30
    v_sub_f32 v19, v19, v30
    v_cvt_pk_bf16_f32 v19, v18, v19
    v_lshlrev_b32 v18, 16, v19
    v_and_b32 v19, 0xffff0000, v19
    v_mul_f32 v18, v18, v32
    v_mul_f32 v19, v19, v32
    v_cvt_pk_bf16_f32 v18, v18, v18
    v_cvt_pk_bf16_f32 v19, v19, v19
    ds_write_b64 v1, v[18:19] offset:32792
    v_sub_f32 v20, v20, v30
    v_sub_f32 v21, v21, v30
    v_cvt_pk_bf16_f32 v21, v20, v21
    v_lshlrev_b32 v20, 16, v21
    v_and_b32 v21, 0xffff0000, v21
    v_mul_f32 v20, v20, v32
    v_mul_f32 v21, v21, v32
    v_cvt_pk_bf16_f32 v20, v20, v20
    v_cvt_pk_bf16_f32 v21, v21, v21
    ds_write_b64 v1, v[20:21] offset:32800
    v_sub_f32 v22, v22, v30
    v_sub_f32 v23, v23, v30
    v_cvt_pk_bf16_f32 v23, v22, v23
    v_lshlrev_b32 v22, 16, v23
    v_and_b32 v23, 0xffff0000, v23
    v_mul_f32 v22, v22, v32
    v_mul_f32 v23, v23, v32
    v_cvt_pk_bf16_f32 v22, v22, v22
    v_cvt_pk_bf16_f32 v23, v23, v23
    ds_write_b64 v1, v[22:23] offset:32808
    v_sub_f32 v24, v24, v30
    v_sub_f32 v25, v25, v30
    v_cvt_pk_bf16_f32 v25, v24, v25
    v_lshlrev_b32 v24, 16, v25
    v_and_b32 v25, 0xffff0000, v25
    v_mul_f32 v24, v24, v32
    v_mul_f32 v25, v25, v32
    v_cvt_pk_bf16_f32 v24, v24, v24
    v_cvt_pk_bf16_f32 v25, v25, v25
    ds_write_b64 v1, v[24:25] offset:32816
    v_sub_f32 v26, v26, v30
    v_sub_f32 v27, v27, v30
    v_cvt_pk_bf16_f32 v27, v26, v27
    v_lshlrev_b32 v26, 16, v27
    v_and_b32 v27, 0xffff0000, v27
    v_mul_f32 v26, v26, v32
    v_mul_f32 v27, v27, v32
    v_cvt_pk_bf16_f32 v26, v26, v26
    v_cvt_pk_bf16_f32 v27, v27, v27
    ds_write_b64 v1, v[26:27] offset:32824
    v_sub_f32 v28, v28, v30
    v_sub_f32 v29, v29, v30
    v_cvt_pk_bf16_f32 v29, v28, v29
    v_lshlrev_b32 v28, 16, v29
    v_and_b32 v29, 0xffff0000, v29
    v_mul_f32 v28, v28, v32
    v_mul_f32 v29, v29, v32
    v_cvt_pk_bf16_f32 v28, v28, v28
    v_cvt_pk_bf16_f32 v29, v29, v29
    ds_write_b64 v1, v[28:29] offset:32832
    s_cmp_lt_u32 s2, 192
    s_cbranch_scc1 L_b1
    ds_read_b64 v[168:169], v82 offset:32768
    ds_read_b64 v[186:187], v82 offset:35072
    ds_read_b64 v[170:171], v82 offset:32776
    ds_read_b64 v[188:189], v82 offset:35080
    ds_read_b64 v[172:173], v82 offset:32784
    ds_read_b64 v[190:191], v82 offset:35088
    ds_read_b64 v[174:175], v82 offset:32792
    ds_read_b64 v[192:193], v82 offset:35096
    ds_read_b64 v[176:177], v82 offset:32800
    ds_read_b64 v[194:195], v82 offset:35104
    ds_read_b64 v[178:179], v82 offset:32808
    ds_read_b64 v[196:197], v82 offset:35112
    ds_read_b64 v[180:181], v82 offset:32816
    ds_read_b64 v[198:199], v82 offset:35120
    ds_read_b64 v[182:183], v82 offset:32824
    ds_read_b64 v[200:201], v82 offset:35128
    ds_read_b64 v[184:185], v82 offset:32832
    ds_read_b64 v[202:203], v82 offset:35136
    s_waitcnt lgkmcnt(15)
    v_and_b32 v40, v168, v36
    v_and_b32 v41, v168, v37
    v_and_b32 v42, v168, v38
    v_and_b32 v43, v168, v39
    v_and_b32 v44, v186, v36
    v_and_b32 v45, v186, v37
    v_and_b32 v46, v186, v38
    v_and_b32 v47, v186, v39
    s_waitcnt vmcnt(17)
    v_mfma_f32_16x16x32_bf16 v[56:59], v[40:43], v[96:99], v[56:59]
    v_mfma_f32_16x16x32_bf16 v[60:63], v[44:47], v[96:99], v[60:63]
    v_and_b32 v40, v169, v36
    v_and_b32 v41, v169, v37
    v_and_b32 v42, v169, v38
    v_and_b32 v43, v169, v39
    v_and_b32 v44, v187, v36
    v_and_b32 v45, v187, v37
    v_and_b32 v46, v187, v38
    v_and_b32 v47, v187, v39
    s_waitcnt vmcnt(16)
    v_mfma_f32_16x16x32_bf16 v[56:59], v[40:43], v[100:103], v[56:59]
    v_mfma_f32_16x16x32_bf16 v[60:63], v[44:47], v[100:103], v[60:63]
    s_waitcnt lgkmcnt(14)
    v_and_b32 v40, v170, v36
    v_and_b32 v41, v170, v37
    v_and_b32 v42, v170, v38
    v_and_b32 v43, v170, v39
    v_and_b32 v44, v188, v36
    v_and_b32 v45, v188, v37
    v_and_b32 v46, v188, v38
    v_and_b32 v47, v188, v39
    s_waitcnt vmcnt(15)
    v_mfma_f32_16x16x32_bf16 v[56:59], v[40:43], v[104:107], v[56:59]
    v_mfma_f32_16x16x32_bf16 v[60:63], v[44:47], v[104:107], v[60:63]
    v_and_b32 v40, v171, v36
    v_and_b32 v41, v171, v37
    v_and_b32 v42, v171, v38
    v_and_b32 v43, v171, v39
    v_and_b32 v44, v189, v36
    v_and_b32 v45, v189, v37
    v_and_b32 v46, v189, v38
    v_and_b32 v47, v189, v39
    s_waitcnt vmcnt(14)
    v_mfma_f32_16x16x32_bf16 v[56:59], v[40:43], v[108:111], v[56:59]
    v_mfma_f32_16x16x32_bf16 v[60:63], v[44:47], v[108:111], v[60:63]
    s_waitcnt lgkmcnt(12)
    v_and_b32 v40, v172, v36
    v_and_b32 v41, v172, v37
    v_and_b32 v42, v172, v38
    v_and_b32 v43, v172, v39
    v_and_b32 v44, v190, v36
    v_and_b32 v45, v190, v37
    v_and_b32 v46, v190, v38
    v_and_b32 v47, v190, v39
    s_waitcnt vmcnt(13)
    v_mfma_f32_16x16x32_bf16 v[56:59], v[40:43], v[112:115], v[56:59]
    v_mfma_f32_16x16x32_bf16 v[60:63], v[44:47], v[112:115], v[60:63]
    v_and_b32 v40, v173, v36
    v_and_b32 v41, v173, v37
    v_and_b32 v42, v173, v38
    v_and_b32 v43, v173, v39
    v_and_b32 v44, v191, v36
    v_and_b32 v45, v191, v37
    v_and_b32 v46, v191, v38
    v_and_b32 v47, v191, v39
    s_waitcnt vmcnt(12)
    v_mfma_f32_16x16x32_bf16 v[56:59], v[40:43], v[116:119], v[56:59]
    v_mfma_f32_16x16x32_bf16 v[60:63], v[44:47], v[116:119], v[60:63]
    s_waitcnt lgkmcnt(10)
    v_and_b32 v40, v174, v36
    v_and_b32 v41, v174, v37
    v_and_b32 v42, v174, v38
    v_and_b32 v43, v174, v39
    v_and_b32 v44, v192, v36
    v_and_b32 v45, v192, v37
    v_and_b32 v46, v192, v38
    v_and_b32 v47, v192, v39
    s_waitcnt vmcnt(11)
    v_mfma_f32_16x16x32_bf16 v[56:59], v[40:43], v[120:123], v[56:59]
    v_mfma_f32_16x16x32_bf16 v[60:63], v[44:47], v[120:123], v[60:63]
    v_and_b32 v40, v175, v36
    v_and_b32 v41, v175, v37
    v_and_b32 v42, v175, v38
    v_and_b32 v43, v175, v39
    v_and_b32 v44, v193, v36
    v_and_b32 v45, v193, v37
    v_and_b32 v46, v193, v38
    v_and_b32 v47, v193, v39
    s_waitcnt vmcnt(10)
    v_mfma_f32_16x16x32_bf16 v[56:59], v[40:43], v[124:127], v[56:59]
    v_mfma_f32_16x16x32_bf16 v[60:63], v[44:47], v[124:127], v[60:63]
    s_waitcnt lgkmcnt(8)
    v_and_b32 v40, v176, v36
    v_and_b32 v41, v176, v37
    v_and_b32 v42, v176, v38
    v_and_b32 v43, v176, v39
    v_and_b32 v44, v194, v36
    v_and_b32 v45, v194, v37
    v_and_b32 v46, v194, v38
    v_and_b32 v47, v194, v39
    s_waitcnt vmcnt(9)
    v_mfma_f32_16x16x32_bf16 v[56:59], v[40:43], v[128:131], v[56:59]
    v_mfma_f32_16x16x32_bf16 v[60:63], v[44:47], v[128:131], v[60:63]
    v_and_b32 v40, v177, v36
    v_and_b32 v41, v177, v37
    v_and_b32 v42, v177, v38
    v_and_b32 v43, v177, v39
    v_and_b32 v44, v195, v36
    v_and_b32 v45, v195, v37
    v_and_b32 v46, v195, v38
    v_and_b32 v47, v195, v39
    s_waitcnt vmcnt(8)
    v_mfma_f32_16x16x32_bf16 v[56:59], v[40:43], v[132:135], v[56:59]
    v_mfma_f32_16x16x32_bf16 v[60:63], v[44:47], v[132:135], v[60:63]
    s_waitcnt lgkmcnt(6)
    v_and_b32 v40, v178, v36
    v_and_b32 v41, v178, v37
    v_and_b32 v42, v178, v38
    v_and_b32 v43, v178, v39
    v_and_b32 v44, v196, v36
    v_and_b32 v45, v196, v37
    v_and_b32 v46, v196, v38
    v_and_b32 v47, v196, v39
    s_waitcnt vmcnt(7)
    v_mfma_f32_16x16x32_bf16 v[56:59], v[40:43], v[136:139], v[56:59]
    v_mfma_f32_16x16x32_bf16 v[60:63], v[44:47], v[136:139], v[60:63]
    v_and_b32 v40, v179, v36
    v_and_b32 v41, v179, v37
    v_and_b32 v42, v179, v38
    v_and_b32 v43, v179, v39
    v_and_b32 v44, v197, v36
    v_and_b32 v45, v197, v37
    v_and_b32 v46, v197, v38
    v_and_b32 v47, v197, v39
    s_waitcnt vmcnt(6)
    v_mfma_f32_16x16x32_bf16 v[56:59], v[40:43], v[140:143], v[56:59]
    v_mfma_f32_16x16x32_bf16 v[60:63], v[44:47], v[140:143], v[60:63]
    s_waitcnt lgkmcnt(4)
    v_and_b32 v40, v180, v36
    v_and_b32 v41, v180, v37
    v_and_b32 v42, v180, v38
    v_and_b32 v43, v180, v39
    v_and_b32 v44, v198, v36
    v_and_b32 v45, v198, v37
    v_and_b32 v46, v198, v38
    v_and_b32 v47, v198, v39
    s_waitcnt vmcnt(5)
    v_mfma_f32_16x16x32_bf16 v[56:59], v[40:43], v[144:147], v[56:59]
    v_mfma_f32_16x16x32_bf16 v[60:63], v[44:47], v[144:147], v[60:63]
    v_and_b32 v40, v181, v36
    v_and_b32 v41, v181, v37
    v_and_b32 v42, v181, v38
    v_and_b32 v43, v181, v39
    v_and_b32 v44, v199, v36
    v_and_b32 v45, v199, v37
    v_and_b32 v46, v199, v38
    v_and_b32 v47, v199, v39
    s_waitcnt vmcnt(4)
    v_mfma_f32_16x16x32_bf16 v[56:59], v[40:43], v[148:151], v[56:59]
    v_mfma_f32_16x16x32_bf16 v[60:63], v[44:47], v[148:151], v[60:63]
    s_waitcnt lgkmcnt(2)
    v_and_b32 v40, v182, v36
    v_and_b32 v41, v182, v37
    v_and_b32 v42, v182, v38
    v_and_b32 v43, v182, v39
    v_and_b32 v44, v200, v36
    v_and_b32 v45, v200, v37
    v_and_b32 v46, v200, v38
    v_and_b32 v47, v200, v39
    s_waitcnt vmcnt(3)
    v_mfma_f32_16x16x32_bf16 v[56:59], v[40:43], v[152:155], v[56:59]
    v_mfma_f32_16x16x32_bf16 v[60:63], v[44:47], v[152:155], v[60:63]
    v_and_b32 v40, v183, v36
    v_and_b32 v41, v183, v37
    v_and_b32 v42, v183, v38
    v_and_b32 v43, v183, v39
    v_and_b32 v44, v201, v36
    v_and_b32 v45, v201, v37
    v_and_b32 v46, v201, v38
    v_and_b32 v47, v201, v39
    s_waitcnt vmcnt(2)
    v_mfma_f32_16x16x32_bf16 v[56:59], v[40:43], v[156:159], v[56:59]
    v_mfma_f32_16x16x32_bf16 v[60:63], v[44:47], v[156:159], v[60:63]
    s_waitcnt lgkmcnt(0)
    v_and_b32 v40, v184, v36
    v_and_b32 v41, v184, v37
    v_and_b32 v42, v184, v38
    v_and_b32 v43, v184, v39
    v_and_b32 v44, v202, v36
    v_and_b32 v45, v202, v37
    v_and_b32 v46, v202, v38
    v_and_b32 v47, v202, v39
    s_waitcnt vmcnt(1)
    v_mfma_f32_16x16x32_bf16 v[56:59], v[40:43], v[160:163], v[56:59]
    v_mfma_f32_16x16x32_bf16 v[60:63], v[44:47], v[160:163], v[60:63]
    v_and_b32 v40, v185, v36
    v_and_b32 v41, v185, v37
    v_and_b32 v42, v185, v38
    v_and_b32 v43, v185, v39
    v_and_b32 v44, v203, v36
    v_and_b32 v45, v203, v37
    v_and_b32 v46, v203, v38
    v_and_b32 v47, v203, v39
    s_waitcnt vmcnt(0)
    v_mfma_f32_16x16x32_bf16 v[56:59], v[40:43], v[164:167], v[56:59]
    v_mfma_f32_16x16x32_bf16 v[60:63], v[44:47], v[164:167], v[60:63]
    s_nop 6
    v_mov_b32_dpp v40, v56 row_ror:8 row_mask:0xf bank_mask:0xf
    v_mov_b32_dpp v44, v60 row_ror:8 row_mask:0xf bank_mask:0xf
    v_mov_b32_dpp v41, v57 row_ror:8 row_mask:0xf bank_mask:0xf
    v_mov_b32_dpp v45, v61 row_ror:8 row_mask:0xf bank_mask:0xf
    v_mov_b32_dpp v42, v58 row_ror:8 row_mask:0xf bank_mask:0xf
    v_mov_b32_dpp v46, v62 row_ror:8 row_mask:0xf bank_mask:0xf
    v_mov_b32_dpp v43, v59 row_ror:8 row_mask:0xf bank_mask:0xf
    v_mov_b32_dpp v47, v63 row_ror:8 row_mask:0xf bank_mask:0xf
    v_permlane32_swap_b32 v40, v44
    v_permlane32_swap_b32 v41, v45
    v_permlane32_swap_b32 v42, v46
    v_permlane32_swap_b32 v43, v47
    v_add_f32_dpp v252, v44, v56 quad_perm:[0,1,2,3] row_mask:0x3 bank_mask:0xf
    v_add_f32_dpp v253, v45, v57 quad_perm:[0,1,2,3] row_mask:0x3 bank_mask:0xf
    v_add_f32_dpp v254, v46, v58 quad_perm:[0,1,2,3] row_mask:0x3 bank_mask:0xf
    v_add_f32_dpp v255, v47, v59 quad_perm:[0,1,2,3] row_mask:0x3 bank_mask:0xf
    v_add_f32_dpp v252, v40, v60 quad_perm:[0,1,2,3] row_mask:0xc bank_mask:0xf
    v_add_f32_dpp v253, v41, v61 quad_perm:[0,1,2,3] row_mask:0xc bank_mask:0xf
    v_add_f32_dpp v254, v42, v62 quad_perm:[0,1,2,3] row_mask:0xc bank_mask:0xf
    v_add_f32_dpp v255, v43, v63 quad_perm:[0,1,2,3] row_mask:0xc bank_mask:0xf
    v_lshlrev_b32 v80, 4, v0
    v_mov_b32 v30, 0
    s_cmp_eq_u32 s38, 0
    s_cbranch_scc1 L_qs
    s_lshl_b32 s40, s38, 10
    v_add_u32 v80, s40, v80
    s_lshl_b32 s40, s38, 2
    v_mov_b32 v30, s40
    ds_write_b128 v80, v[252:255] offset:38400
    ds_write_b32 v30, v84 offset:44608
    s_branch L_b1
L_qs:
    s_lshl_b32 s40, s51, 9
    s_add_u32 s40, s40, 1310720
    v_lshrrev_b32 v248, 4, v0
    v_lshl_or_b32 v248, v248, 7, v83
    v_add_u32 v248, s40, v248
    s_mov_b32 s42, 131072
L_qw:
    ds_read_b128 v[40:43], v30 offset:44608
    ds_read_b128 v[100:103], v80 offset:39424
    ds_read_b128 v[104:107], v80 offset:40448
    ds_read_b128 v[108:111], v80 offset:41472
    s_sub_u32 s42, s42, 1
    s_cbranch_scc1 L_qx
    s_waitcnt lgkmcnt(0)
    v_min3_u32 v40, v41, v42, v43
    v_cmp_eq_u32 vcc, 0, v40
    s_cbranch_vccnz L_qw
L_qx:
    v_add_f32 v252, v252, v100
    v_add_f32 v104, v104, v108
    v_add_f32 v252, v252, v104
    v_add_f32 v253, v253, v101
    v_add_f32 v105, v105, v109
    v_add_f32 v253, v253, v105
    v_add_f32 v254, v254, v102
    v_add_f32 v106, v106, v110
    v_add_f32 v254, v254, v106
    v_add_f32 v255, v255, v103
    v_add_f32 v107, v107, v111
    v_add_f32 v255, v255, v107
    v_cvt_pk_bf16_f32 v252, v252, v252
    v_lshl_or_b32 v252, v252, 16, s80
    v_cvt_pk_bf16_f32 v253, v253, v253
    v_lshl_or_b32 v253, v253, 16, s80
    v_cvt_pk_bf16_f32 v254, v254, v254
    v_lshl_or_b32 v254, v254, 16, s80
    v_cvt_pk_bf16_f32 v255, v255, v255
    v_lshl_or_b32 v255, v255, 16, s80
    s_mov_b32 exec_lo, 0xff00ff
    s_mov_b32 exec_hi, 0xff00ff00
    global_store_dwordx4 v248, v[252:255], s[30:31] sc1
    s_mov_b64 exec, -1
    s_branch L_b1
L_hother:
    s_waitcnt lgkmcnt(0)
    s_load_dword s53, s[30:31], 1048320
    s_barrier
    v_mov_b32 v31, 0xffff
    v_and_b32 v30, 1, v0
    v_lshlrev_b32 v30, 4, v30
    v_lshlrev_b32 v30, v30, v31
    v_bfe_u32 v31, v0, 1, 2
    v_cmp_eq_u32 vcc, 0, v31
    s_nop 1
    v_cndmask_b32 v36, 0, v30, vcc
    v_cmp_eq_u32 vcc, 1, v31
    s_nop 1
    v_cndmask_b32 v37, 0, v30, vcc
    v_cmp_eq_u32 vcc, 2, v31
    s_nop 1
    v_cndmask_b32 v38, 0, v30, vcc
    v_cmp_eq_u32 vcc, 3, v31
    s_nop 1
    v_cndmask_b32 v39, 0, v30, vcc
    v_mov_b32 v84, 0xff
    s_waitcnt lgkmcnt(0)
    s_mul_i32 s54, s53, 0x9e3779b1
    s_add_u32 s54, s54, 0x7f4a7c15
    s_and_b32 s76, s54, 0xff
    s_bfe_u32 s77, s54, 0x80008
    s_bfe_u32 s78, s54, 0x80010
    s_lshr_b32 s79, s54, 24
    s_and_b32 s80, s54, 0xffff
L_b1:
    v_lshrrev_b32 v31, 4, v0
    v_lshlrev_b32 v85, 4, v0
    v_mov_b32 v34, 0
    s_and_b32 s40, s4, 7
    s_mul_i32 s56, s4, 7
    s_add_u32 s56, s56, s6
    s_cmp_gt_u32 s6, s40
    s_subb_u32 s56, s56, 0
    s_cmp_eq_u32 s6, s40
    s_cselect_b32 s57, 1, 0
    s_cmp_eq_u32 s5, 0
    s_cselect_b32 s57, 1, s57
    s_cselect_b32 s55, s6, 8
    s_waitcnt lgkmcnt(0)
    s_cmp_eq_u32 s38, 0
    s_cbranch_scc1 L_h0
    s_cmp_eq_u32 s57, 0
    s_cbranch_scc1 L_dn
    s_cmp_eq_u32 s38, 2
    s_cbranch_scc1 L_hw
    s_cmp_ge_u32 s2, 72
    s_cbranch_scc1 L_hw
    v_mov_b32 v56, 0
    v_mov_b32 v57, 0
    v_mov_b32 v58, 0
    v_mov_b32 v59, 0
    v_mov_b32 v60, 0
    v_mov_b32 v61, 0
    v_mov_b32 v62, 0
    v_mov_b32 v63, 0
    s_lshl_b32 s40, s2, 7
    s_add_u32 s48, s20, s40
    s_addc_u32 s49, s21, 0
    s_cmp_eq_u32 s38, 1
    s_cbranch_scc1 L_ga
    s_add_u32 s48, s22, s40
    s_addc_u32 s49, s23, 0
L_ga:
    v_mul_u32_u24 v80, 663552, v81
    v_add_u32 v80, v80, v83
    v_mul_u32_u24 v82, 288, v81
    v_mov_b32 v31, 0
    s_mov_b32 s42, 131072
L_fx:
    ds_read_b32 v30, v31 offset:44640
    s_sub_u32 s42, s42, 1
    s_cbranch_scc1 L_fxx
    s_waitcnt lgkmcnt(0)
    v_cmp_eq_u32 vcc, 0, v30
    s_cbranch_vccnz L_fx
L_fxx:
    s_waitcnt lgkmcnt(0)
    v_lshrrev_b32 v31, 4, v0
    s_mov_b32 s42, 36
L_gu:
    ds_read_b64 v[48:49], v82 offset:32768
    ds_read_b64 v[52:53], v82 offset:35072
    v_add_u32 v82, 8, v82
    global_load_dwordx4 v[96:99], v80, s[48:49] nt
    v_add_u32 v80, 9216, v80
    global_load_dwordx4 v[100:103], v80, s[48:49] nt
    v_add_u32 v80, 9216, v80
    s_waitcnt vmcnt(0) lgkmcnt(0)
    v_and_b32 v40, v48, v36
    v_and_b32 v44, v52, v36
    v_and_b32 v41, v48, v37
    v_and_b32 v45, v52, v37
    v_and_b32 v42, v48, v38
    v_and_b32 v46, v52, v38
    v_and_b32 v43, v48, v39
    v_and_b32 v47, v52, v39
    s_nop 0
    v_mfma_f32_16x16x32_bf16 v[56:59], v[40:43], v[96:99], v[56:59]
    v_mfma_f32_16x16x32_bf16 v[60:63], v[44:47], v[96:99], v[60:63]
    v_and_b32 v40, v49, v36
    v_and_b32 v44, v53, v36
    v_and_b32 v41, v49, v37
    v_and_b32 v45, v53, v37
    v_and_b32 v42, v49, v38
    v_and_b32 v46, v53, v38
    v_and_b32 v43, v49, v39
    v_and_b32 v47, v53, v39
    s_nop 0
    v_mfma_f32_16x16x32_bf16 v[56:59], v[40:43], v[100:103], v[56:59]
    v_mfma_f32_16x16x32_bf16 v[60:63], v[44:47], v[100:103], v[60:63]
    s_sub_u32 s42, s42, 1
    s_cmp_lg_u32 s42, 0
    s_cbranch_scc1 L_gu
    s_nop 3
    v_mov_b32_dpp v40, v56 row_ror:8 row_mask:0xf bank_mask:0xf
    v_mov_b32_dpp v44, v60 row_ror:8 row_mask:0xf bank_mask:0xf
    v_mov_b32_dpp v41, v57 row_ror:8 row_mask:0xf bank_mask:0xf
    v_mov_b32_dpp v45, v61 row_ror:8 row_mask:0xf bank_mask:0xf
    v_mov_b32_dpp v42, v58 row_ror:8 row_mask:0xf bank_mask:0xf
    v_mov_b32_dpp v46, v62 row_ror:8 row_mask:0xf bank_mask:0xf
    v_mov_b32_dpp v43, v59 row_ror:8 row_mask:0xf bank_mask:0xf
    v_mov_b32_dpp v47, v63 row_ror:8 row_mask:0xf bank_mask:0xf
    v_permlane32_swap_b32 v40, v44
    v_permlane32_swap_b32 v41, v45
    v_permlane32_swap_b32 v42, v46
    v_permlane32_swap_b32 v43, v47
    v_add_f32_dpp v252, v44, v56 quad_perm:[0,1,2,3] row_mask:0x3 bank_mask:0xf
    v_add_f32_dpp v253, v45, v57 quad_perm:[0,1,2,3] row_mask:0x3 bank_mask:0xf
    v_add_f32_dpp v254, v46, v58 quad_perm:[0,1,2,3] row_mask:0x3 bank_mask:0xf
    v_add_f32_dpp v255, v47, v59 quad_perm:[0,1,2,3] row_mask:0x3 bank_mask:0xf
    v_add_f32_dpp v252, v40, v60 quad_perm:[0,1,2,3] row_mask:0xc bank_mask:0xf
    v_add_f32_dpp v253, v41, v61 quad_perm:[0,1,2,3] row_mask:0xc bank_mask:0xf
    v_add_f32_dpp v254, v42, v62 quad_perm:[0,1,2,3] row_mask:0xc bank_mask:0xf
    v_add_f32_dpp v255, v43, v63 quad_perm:[0,1,2,3] row_mask:0xc bank_mask:0xf
    v_cvt_pk_bf16_f32 v252, v252, v252
    v_and_b32 v252, 0xffff0000, v252
    v_cvt_pk_bf16_f32 v253, v253, v253
    v_and_b32 v253, 0xffff0000, v253
    v_cvt_pk_bf16_f32 v254, v254, v254
    v_and_b32 v254, 0xffff0000, v254
    v_cvt_pk_bf16_f32 v255, v255, v255
    v_and_b32 v255, 0xffff0000, v255
    s_cmp_eq_u32 s38, 3
    s_cbranch_scc1 L_up
    ds_write_b128 v85, v[252:255] offset:42560
    ds_write_b32 v34, v84 offset:44624
    s_branch L_hw
L_up:
    s_lshl_b32 s40, s2, 9
    s_add_u32 s40, s40, 1376256
    v_lshl_or_b32 v248, v31, 7, v83
    v_add_u32 v248, s40, v248
    v_mov_b32 v31, 0
    s_mov_b32 s42, 131072
L_fg:
    ds_read_b32 v30, v31 offset:44624
    ds_read_b128 v[48:51], v85 offset:42560
    s_sub_u32 s42, s42, 1
    s_cbranch_scc1 L_fgx
    s_waitcnt lgkmcnt(0)
    v_cmp_eq_u32 vcc, 0, v30
    s_cbranch_vccnz L_fg
L_fgx:
    s_waitcnt lgkmcnt(0)
    v_max_f32 v48, 0, v48
    v_mul_f32 v252, v252, v48
    v_max_f32 v49, 0, v49
    v_mul_f32 v253, v253, v49
    v_max_f32 v50, 0, v50
    v_mul_f32 v254, v254, v50
    v_max_f32 v51, 0, v51
    v_mul_f32 v255, v255, v51
    v_cvt_pk_bf16_f32 v252, v252, v252
    v_lshl_or_b32 v252, v252, 16, s80
    v_cvt_pk_bf16_f32 v253, v253, v253
    v_lshl_or_b32 v253, v253, 16, s80
    v_cvt_pk_bf16_f32 v254, v254, v254
    v_lshl_or_b32 v254, v254, 16, s80
    v_cvt_pk_bf16_f32 v255, v255, v255
    v_lshl_or_b32 v255, v255, 16, s80
    s_mov_b32 exec_lo, 0xff00ff
    s_mov_b32 exec_hi, 0xff00ff00
    global_store_dwordx4 v248, v[252:255], s[30:31] sc1
    s_mov_b64 exec, -1
L_hw:
    s_lshl_b32 s39, s4, 1
    s_lshr_b32 s40, s3, 2
    s_add_u32 s39, s39, s40
    s_lshl_b32 s39, s39, 1
    s_and_b32 s40, s3, 1
    s_add_u32 s39, s39, s40
    s_lshl_b32 s39, s39, 5
    s_and_b32 s40, s3, 2
    s_add_u32 s39, s39, s40
    s_mul_i32 s39, s39, 2304
    s_lshl_b32 s40, s55, 7
    s_add_u32 s39, s39, s40
    s_add_u32 s44, s16, s39
    s_addc_u32 s45, s17, 0
    v_lshrrev_b32 v170, 3, v0
    v_mul_u32_u24 v170, 9216, v170
    v_and_b32 v171, 7, v0
    v_lshl_add_u32 v170, v171, 4, v170
    v_mov_b32 v4, v36
    v_mov_b32 v5, v37
    v_mov_b32 v6, v38
    v_mov_b32 v7, v39
    s_mov_b32 s42, 131072
    s_mov_b32 s41, 64
L_lw:
    ds_read_b32 v30, v34 offset:43584
    s_sub_u32 s42, s42, 1
    s_cbranch_scc1 L_lwx
    s_waitcnt lgkmcnt(0)
    v_cmp_gt_u32 vcc, s41, v30
    s_cbranch_vccnz L_lw
L_lwx:
    global_load_dwordx4 v[112:115], v170, s[44:45] offset:0 nt
    global_load_dwordx4 v[116:119], v170, s[44:45] offset:1152 nt
    global_load_dwordx4 v[120:123], v170, s[44:45] offset:2304 nt
    global_load_dwordx4 v[124:127], v170, s[44:45] offset:3456 nt
    s_branch L_b2
L_dp:
L_h0:
    ds_write_b32 v34, v84 offset:44640
    v_add_u32 v16, 1, v0
    v_mul_u32_u24 v12, 33, v16
    v_add_u32 v12, s2, v12
    v_lshlrev_b32 v12, 8, v12
    v_mul_u32_u24 v16, 2048, v16
    s_add_u32 s44, s30, 1638400
    s_addc_u32 s45, s31, 0
    s_lshl_b32 s40, s2, 8
    v_lshl_add_u32 v15, v0, 2, s40
    v_and_b32 v13, 3, v0
    v_lshlrev_b32 v13, 8, v13
    v_mov_b32 v14, 0
    s_lshl_b32 s40, s7, 13
    s_lshl_b32 s41, s6, 10
    s_add_u32 s40, s40, s41
    s_add_u32 s40, s40, 1048576
    v_add_u32 v246, s40, v85
    v_lshrrev_b32 v17, 5, v0
    v_lshlrev_b32 v17, 4, v17
    s_lshl_b32 s40, s7, 11
    v_lshl_or_b32 v18, v83, 4, v17
    v_add_u32 v18, s40, v18
    s_lshl_b32 s40, s2, 8
    v_add_u32 v19, s40, v17
    v_mov_b32 v56, 0
    v_mov_b32 v57, 0
    v_mov_b32 v58, 0
    v_mov_b32 v59, 0
    v_mov_b32 v42, s54
    v_mov_b32 v80, v85
    s_mov_b32 s37, 0x3fb8aa3b
    s_mov_b32 s42, 131072
    s_mov_b32 s41, 32
L_ml:
    ds_read_b32 v30, v13 offset:43584
    s_sub_u32 s42, s42, 1
    s_cbranch_scc1 L_mx
    s_waitcnt lgkmcnt(0)
    v_cmp_gt_u32 vcc, s41, v30
    s_cbranch_vccnz L_ml
    ds_read_b128 v[48:51], v14 offset:42496
    ds_read_b128 v[52:55], v14 offset:42512
    s_mov_b32 s41, 4
    s_waitcnt lgkmcnt(0)
    v_min3_f32 v44, v48, v49, v50
    v_min_f32 v44, v44, v51
    v_min3_f32 v45, v52, v53, v54
    v_min_f32 v45, v45, v55
    ds_read_b128 v[48:51], v17 offset:42496
L_ls:
    ds_read_b128 v[96:99], v80 offset:0
    ds_read_b128 v[100:103], v80 offset:1024
    ds_read_b128 v[104:107], v80 offset:2048
    ds_read_b128 v[108:111], v80 offset:3072
    ds_read_b128 v[112:115], v80 offset:4096
    ds_read_b128 v[116:119], v80 offset:5120
    ds_read_b128 v[120:123], v80 offset:6144
    ds_read_b128 v[124:127], v80 offset:7168
    v_add_u32 v80, 0x2000, v80
    s_waitcnt lgkmcnt(7)
    v_fma_f32 v96, v96, s37, v44
    v_fma_f32 v97, v97, s37, v45
    v_fma_f32 v98, v98, s37, v44
    v_fma_f32 v99, v99, s37, v45
    v_exp_f32 v96, v96
    v_exp_f32 v97, v97
    v_exp_f32 v98, v98
    v_exp_f32 v99, v99
    v_pk_add_f32 v[56:57], v[56:57], v[96:97]
    v_pk_add_f32 v[58:59], v[58:59], v[98:99]
    s_waitcnt lgkmcnt(6)
    v_fma_f32 v100, v100, s37, v44
    v_fma_f32 v101, v101, s37, v45
    v_fma_f32 v102, v102, s37, v44
    v_fma_f32 v103, v103, s37, v45
    v_exp_f32 v100, v100
    v_exp_f32 v101, v101
    v_exp_f32 v102, v102
    v_exp_f32 v103, v103
    v_pk_add_f32 v[56:57], v[56:57], v[100:101]
    v_pk_add_f32 v[58:59], v[58:59], v[102:103]
    s_waitcnt lgkmcnt(5)
    v_fma_f32 v104, v104, s37, v44
    v_fma_f32 v105, v105, s37, v45
    v_fma_f32 v106, v106, s37, v44
    v_fma_f32 v107, v107, s37, v45
    v_exp_f32 v104, v104
    v_exp_f32 v105, v105
    v_exp_f32 v106, v106
    v_exp_f32 v107, v107
    v_pk_add_f32 v[56:57], v[56:57], v[104:105]
    v_pk_add_f32 v[58:59], v[58:59], v[106:107]
    s_waitcnt lgkmcnt(4)
    v_fma_f32 v108, v108, s37, v44
    v_fma_f32 v109, v109, s37, v45
    v_fma_f32 v110, v110, s37, v44
    v_fma_f32 v111, v111, s37, v45
    v_exp_f32 v108, v108
    v_exp_f32 v109, v109
    v_exp_f32 v110, v110
    v_exp_f32 v111, v111
    v_pk_add_f32 v[56:57], v[56:57], v[108:109]
    v_pk_add_f32 v[58:59], v[58:59], v[110:111]
    s_waitcnt lgkmcnt(3)
    v_fma_f32 v112, v112, s37, v44
    v_fma_f32 v113, v113, s37, v45
    v_fma_f32 v114, v114, s37, v44
    v_fma_f32 v115, v115, s37, v45
    v_exp_f32 v112, v112
    v_exp_f32 v113, v113
    v_exp_f32 v114, v114
    v_exp_f32 v115, v115
    v_pk_add_f32 v[56:57], v[56:57], v[112:113]
    v_pk_add_f32 v[58:59], v[58:59], v[114:115]
    s_waitcnt lgkmcnt(2)
    v_fma_f32 v116, v116, s37, v44
    v_fma_f32 v117, v117, s37, v45
    v_fma_f32 v118, v118, s37, v44
    v_fma_f32 v119, v119, s37, v45
    v_exp_f32 v116, v116
    v_exp_f32 v117, v117
    v_exp_f32 v118, v118
    v_exp_f32 v119, v119
    v_pk_add_f32 v[56:57], v[56:57], v[116:117]
    v_pk_add_f32 v[58:59], v[58:59], v[118:119]
    s_waitcnt lgkmcnt(1)
    v_fma_f32 v120, v120, s37, v44
    v_fma_f32 v121, v121, s37, v45
    v_fma_f32 v122, v122, s37, v44
    v_fma_f32 v123, v123, s37, v45
    v_exp_f32 v120, v120
    v_exp_f32 v121, v121
    v_exp_f32 v122, v122
    v_exp_f32 v123, v123
    v_pk_add_f32 v[56:57], v[56:57], v[120:121]
    v_pk_add_f32 v[58:59], v[58:59], v[122:123]
    s_waitcnt lgkmcnt(0)
    v_fma_f32 v124, v124, s37, v44
    v_fma_f32 v125, v125, s37, v45
    v_fma_f32 v126, v126, s37, v44
    v_fma_f32 v127, v127, s37, v45
    v_exp_f32 v124, v124
    v_exp_f32 v125, v125
    v_exp_f32 v126, v126
    v_exp_f32 v127, v127
    v_pk_add_f32 v[56:57], v[56:57], v[124:125]
    v_pk_add_f32 v[58:59], v[58:59], v[126:127]
    s_sub_u32 s41, s41, 1
    s_cmp_lg_u32 s41, 0
    s_cbranch_scc1 L_ls
    v_pk_add_f32 v[56:57], v[56:57], v[58:59]
    s_nop 1
    v_permlane32_swap_b32 v56, v57
    v_add_f32 v41, v56, v57
    s_nop 1
    v_add_f32_dpp v41, v41, v41 quad_perm:[1,0,3,2] row_mask:0xf bank_mask:0xf
    s_nop 1
    v_add_f32_dpp v41, v41, v41 quad_perm:[2,3,0,1] row_mask:0xf bank_mask:0xf
    s_nop 1
    v_add_f32_dpp v41, v41, v41 row_ror:4 row_mask:0xf bank_mask:0xf
    s_nop 1
    v_add_f32_dpp v41, v41, v41 row_ror:8 row_mask:0xf bank_mask:0xf
    v_mov_b32 v30, v41
    s_nop 1
    v_permlane16_swap_b32 v30, v41
    v_add_f32 v41, v41, v30
    v_min3_f32 v40, v48, v49, v50
    v_min_f32 v40, v40, v51
    s_mov_b32 exec_lo, 0x1
    s_mov_b32 exec_hi, 0x1
    global_store_dwordx3 v19, v[40:42], s[44:45] offset:64 sc1
    s_mov_b64 exec, -1
    s_mov_b32 s46, 0x0
    s_mov_b32 s47, 0x4444444
    s_and_b32 s39, s54, 0xffffff00
L_pn:
    s_ff1_i32_b64 s41, s[46:47]
    s_bitset0_b64 s[46:47], s41
    v_and_b32 v12, 0xff00, v12
    s_or_b32 s40, s39, s41
    v_mov_b32 v31, s40
L_pb:
    ds_read_b32 v30, v13 offset:43584
    s_sub_u32 s42, s42, 1
    s_cbranch_scc1 L_mx
    s_waitcnt lgkmcnt(0)
    v_cmp_gt_u32 vcc, s41, v30
    s_cbranch_vccnz L_pb
    s_mov_b32 exec_lo, 0xffff
    s_mov_b32 exec_hi, 0x0
    global_store_dword v15, v31, s[44:45] sc1
    s_mov_b32 exec_lo, 0x7f
    s_mov_b32 exec_hi, 0x0
    global_load_dword v30, v12, s[44:45] sc1
    s_waitcnt vmcnt(0)
    v_sub_u32 v30, v30, v31
    v_cmp_gt_u32 vcc, 64, v30
    s_bcnt1_i32_b64 s40, vcc
    v_mov_b32 v30, s40
    ds_write_b32 v14, v30 offset:44608
    s_mov_b64 exec, -1
    v_add_u32 v12, v12, v16
    s_cmp_lg_u64 s[46:47], 0
    s_cbranch_scc1 L_pn
L_m:
    global_load_dwordx3 v[44:46], v18, s[44:45] offset:64 sc1
    s_sub_u32 s42, s42, 1
    s_cbranch_scc1 L_mx
    s_waitcnt vmcnt(0)
    v_cmp_ne_u32 vcc, s54, v46
    s_mov_b64 exec, vcc
    s_cbranch_vccnz L_m
L_mx:
    s_mov_b64 exec, -1
    v_mov_b32 v30, v44
    s_nop 1
    v_min_f32_dpp v30, v30, v30 quad_perm:[1,0,3,2] row_mask:0xf bank_mask:0xf
    s_nop 1
    v_min_f32_dpp v30, v30, v30 quad_perm:[2,3,0,1] row_mask:0xf bank_mask:0xf
    s_nop 1
    v_min_f32_dpp v30, v30, v30 row_half_mirror row_mask:0xf bank_mask:0xf
    v_sub_f32 v44, v30, v44
    v_exp_f32 v44, v44
    s_nop 0
    v_mul_f32 v44, v44, v45
    s_nop 1
    v_add_f32_dpp v44, v44, v44 quad_perm:[1,0,3,2] row_mask:0xf bank_mask:0xf
    s_nop 1
    v_add_f32_dpp v44, v44, v44 quad_perm:[2,3,0,1] row_mask:0xf bank_mask:0xf
    s_nop 1
    v_add_f32_dpp v44, v44, v44 row_half_mirror row_mask:0xf bank_mask:0xf
    v_rcp_f32 v44, v44
    v_sub_f32 v48, v30, v48
    v_exp_f32 v48, v48
    s_nop 0
    v_mul_f32 v48, v48, v44
    v_sub_f32 v49, v30, v49
    v_exp_f32 v49, v49
    s_nop 0
    v_mul_f32 v49, v49, v44
    v_sub_f32 v50, v30, v50
    v_exp_f32 v50, v50
    s_nop 0
    v_mul_f32 v50, v50, v44
    v_sub_f32 v51, v30, v51
    v_exp_f32 v51, v51
    s_nop 0
    v_mul_f32 v51, v51, v44
    s_lshl_b32 s40, s55, 13
    s_lshl_b32 s41, s4, 7
    s_add_u32 s40, s40, s41
    s_add_u32 s40, s40, 1703936
    v_lshrrev_b32 v30, 5, v0
    v_bfe_u32 v31, v0, 2, 1
    v_lshl_or_b32 v30, v30, 1, v31
    v_mul_u32_u24 v240, 2048, v30
    v_and_b32 v30, 16, v0
    v_lshl_or_b32 v240, v30, 2, v240
    v_and_b32 v30, 3, v0
    v_lshl_or_b32 v240, v30, 4, v240
    v_add_u32 v240, s40, v240
    s_lshl_b32 s40, s4, 13
    s_lshl_b32 s41, s3, 7
    s_add_u32 s40, s40, s41
    s_add_u32 s40, s40, 1048576
    v_lshrrev_b32 v30, 3, v0
    v_and_b32 v31, 7, v0
    v_lshlrev_b32 v31, 4, v31
    v_lshl_or_b32 v243, v30, 10, v31
    v_add_u32 v243, s40, v243
    v_add_u32 v244, 0x20000, v243
    s_lshl_b32 s40, s3, 8
    v_and_or_b32 v30, v0, 8, v30
    v_lshl_add_u32 v80, v30, 4, s40
    v_xor_b32 v81, 16, v80
    v_lshrrev_b32 v30, 5, v0
    v_lshl_or_b32 v31, v30, 7, v31
    v_bfe_u32 v30, v0, 4, 1
    v_lshl_or_b32 v31, v30, 3, v31
    v_add_u32 v250, s40, v31
    s_lshl_b32 s40, s3, 10
    v_lshl_add_u32 v245, v0, 4, s40
    v_mov_b32 v84, 0xff
    s_lshl_b32 s39, s4, 1
    s_lshr_b32 s40, s3, 2
    s_add_u32 s39, s39, s40
    s_lshl_b32 s39, s39, 1
    s_and_b32 s40, s3, 1
    s_add_u32 s39, s39, s40
    s_lshl_b32 s39, s39, 5
    s_and_b32 s40, s3, 2
    s_add_u32 s39, s39, s40
    s_mul_i32 s39, s39, 2304
    s_lshl_b32 s40, s55, 7
    s_add_u32 s39, s39, s40
    s_add_u32 s44, s16, s39
    s_addc_u32 s45, s17, 0
    v_lshrrev_b32 v170, 3, v0
    v_mul_u32_u24 v170, 9216, v170
    v_and_b32 v171, 7, v0
    v_lshl_add_u32 v170, v171, 4, v170
    v_mov_b32 v4, v36
    v_mov_b32 v5, v37
    v_mov_b32 v6, v38
    v_mov_b32 v7, v39
L_h0b:
    s_barrier
    ds_read_b128 v[96:99], v85 offset:38400
    ds_read_b128 v[100:103], v85 offset:39424
    ds_read_b128 v[104:107], v85 offset:40448
    ds_read_b128 v[108:111], v85 offset:41472
    s_waitcnt lgkmcnt(3)
    v_pk_mul_f32 v[96:97], v[96:97], v[48:49] op_sel:[0,0] op_sel_hi:[1,0]
    v_pk_mul_f32 v[98:99], v[98:99], v[48:49] op_sel:[0,0] op_sel_hi:[1,0]
    s_waitcnt lgkmcnt(2)
    v_pk_fma_f32 v[96:97], v[100:101], v[48:49], v[96:97] op_sel:[0,1,0] op_sel_hi:[1,1,1]
    v_pk_fma_f32 v[98:99], v[102:103], v[48:49], v[98:99] op_sel:[0,1,0] op_sel_hi:[1,1,1]
    s_waitcnt lgkmcnt(1)
    v_pk_fma_f32 v[96:97], v[104:105], v[50:51], v[96:97] op_sel:[0,0,0] op_sel_hi:[1,0,1]
    v_pk_fma_f32 v[98:99], v[106:107], v[50:51], v[98:99] op_sel:[0,0,0] op_sel_hi:[1,0,1]
    s_waitcnt lgkmcnt(0)
    v_pk_fma_f32 v[96:97], v[108:109], v[50:51], v[96:97] op_sel:[0,1,0] op_sel_hi:[1,1,1]
    v_pk_fma_f32 v[98:99], v[110:111], v[50:51], v[98:99] op_sel:[0,1,0] op_sel_hi:[1,1,1]
    v_bfi_b32 v96, v84, s76, v96
    v_bfi_b32 v97, v84, s77, v97
    v_bfi_b32 v98, v84, s78, v98
    v_bfi_b32 v99, v84, s79, v99
    global_store_dwordx4 v246, v[96:99], s[30:31] sc1
    ds_write_b32 v14, v84 offset:44636
    s_cmp_lg_u32 s57, 0
    s_cbranch_scc0 L_hx
    global_load_dwordx4 v[112:115], v170, s[44:45] offset:0 nt
    global_load_dwordx4 v[116:119], v170, s[44:45] offset:1152 nt
    global_load_dwordx4 v[120:123], v170, s[44:45] offset:2304 nt
    global_load_dwordx4 v[124:127], v170, s[44:45] offset:3456 nt
    s_branch L_poll
L_hx:
    s_waitcnt lgkmcnt(0)
L_done:
L_end:
    s_endpgm
L_dn:
    s_cmp_ge_u32 s56, 108
    s_cbranch_scc1 L_done
    s_mul_i32 s55, s56, 57
    s_lshr_b32 s55, s55, 9
    s_mul_i32 s40, s55, 9
    s_sub_u32 s56, s56, s40
    s_mul_i32 s40, s56, 6144
    s_lshl_b32 s41, s55, 7
    s_add_u32 s40, s40, s41
    s_add_u32 s40, s40, 1507328
    v_lshrrev_b32 v30, 5, v0
    v_bfe_u32 v31, v0, 2, 1
    v_lshl_or_b32 v30, v30, 1, v31
    v_mul_u32_u24 v248, 1536, v30
    v_and_b32 v30, 16, v0
    v_lshl_or_b32 v248, v30, 2, v248
    v_and_b32 v30, 3, v0
    v_lshl_or_b32 v248, v30, 4, v248
    v_add_u32 v248, s40, v248
    s_mul_i32 s55, s55, 3
    s_add_u32 s55, s55, s38
    s_sub_u32 s55, s55, 1
    s_mul_i32 s40, s55, 147456
    s_lshl_b32 s41, s56, 7
    s_add_u32 s40, s40, s41
    s_add_u32 s48, s24, s40
    s_addc_u32 s49, s25, 0
    v_mul_u32_u24 v48, 9216, v81
    v_add_u32 v48, v48, v83
    v_add_u32 v49, 4608, v48
    v_add_u32 v50, 73728, v48
    v_add_u32 v51, 73728, v49
    s_lshl_b32 s40, s55, 10
    s_add_u32 s40, s40, 1376256
    v_and_b32 v30, 8, v0
    v_lshl_or_b32 v30, v30, 1, v81
    v_lshl_add_u32 v80, v30, 4, s40
    v_xor_b32 v82, 16, v80
    s_mov_b32 s42, 131072
    s_mov_b32 s41, 44
L_gg:
    ds_read_b32 v30, v34 offset:43584
    s_sub_u32 s42, s42, 1
    s_cbranch_scc1 L_ggx
    s_waitcnt lgkmcnt(0)
    v_cmp_gt_u32 vcc, s41, v30
    s_cbranch_vccnz L_gg
    global_load_dwordx4 v[96:99], v80, s[30:31] offset:0 sc1
    global_load_dwordx4 v[100:103], v82, s[30:31] offset:0 sc1
    global_load_dwordx4 v[104:107], v80, s[30:31] offset:128 sc1
    global_load_dwordx4 v[108:111], v82, s[30:31] offset:128 sc1
    global_load_dwordx4 v[112:115], v80, s[30:31] offset:512 sc1
    global_load_dwordx4 v[116:119], v82, s[30:31] offset:512 sc1
    global_load_dwordx4 v[120:123], v80, s[30:31] offset:640 sc1
    global_load_dwordx4 v[124:127], v82, s[30:31] offset:640 sc1
    s_add_u32 s41, s41, 1
    s_min_u32 s41, s41, 62
    s_waitcnt vmcnt(0)
    v_xor_b32 v96, s80, v96
    v_xor_b32 v97, s80, v97
    v_xor_b32 v98, s80, v98
    v_xor_b32 v99, s80, v99
    v_xor_b32 v100, s80, v100
    v_xor_b32 v101, s80, v101
    v_xor_b32 v102, s80, v102
    v_xor_b32 v103, s80, v103
    v_xor_b32 v104, s80, v104
    v_xor_b32 v105, s80, v105
    v_xor_b32 v106, s80, v106
    v_xor_b32 v107, s80, v107
    v_xor_b32 v108, s80, v108
    v_xor_b32 v109, s80, v109
    v_xor_b32 v110, s80, v110
    v_xor_b32 v111, s80, v111
    v_xor_b32 v112, s80, v112
    v_xor_b32 v113, s80, v113
    v_xor_b32 v114, s80, v114
    v_xor_b32 v115, s80, v115
    v_xor_b32 v116, s80, v116
    v_xor_b32 v117, s80, v117
    v_xor_b32 v118, s80, v118
    v_xor_b32 v119, s80, v119
    v_xor_b32 v120, s80, v120
    v_xor_b32 v121, s80, v121
    v_xor_b32 v122, s80, v122
    v_xor_b32 v123, s80, v123
    v_xor_b32 v124, s80, v124
    v_xor_b32 v125, s80, v125
    v_xor_b32 v126, s80, v126
    v_xor_b32 v127, s80, v127
    v_or3_b32 v30, v96, v97, v98
    v_or3_b32 v30, v30, v99, v100
    v_or3_b32 v30, v30, v101, v102
    v_or3_b32 v30, v30, v103, v104
    v_or3_b32 v30, v30, v105, v106
    v_or3_b32 v30, v30, v107, v108
    v_or3_b32 v30, v30, v109, v110
    v_or3_b32 v30, v30, v111, v112
    v_or3_b32 v30, v30, v113, v114
    v_or3_b32 v30, v30, v115, v116
    v_or3_b32 v30, v30, v117, v118
    v_or3_b32 v30, v30, v119, v120
    v_or3_b32 v30, v30, v121, v122
    v_or3_b32 v30, v30, v123, v124
    v_or3_b32 v30, v30, v125, v126
    v_or_b32 v30, v30, v127
    v_and_b32 v30, 65535, v30
    v_cmp_ne_u32 vcc, 0, v30
    s_mov_b64 exec, vcc
    s_cbranch_vccnz L_gg
L_ggx:
    s_mov_b64 exec, -1
    v_cvt_pk_bf16_f32 v96, v96, v96
    v_and_b32 v160, v96, v36
    v_and_b32 v161, v96, v37
    v_and_b32 v162, v96, v38
    v_and_b32 v163, v96, v39
    v_cvt_pk_bf16_f32 v100, v100, v100
    v_and_b32 v164, v100, v36
    v_and_b32 v165, v100, v37
    v_and_b32 v166, v100, v38
    v_and_b32 v167, v100, v39
    v_cvt_pk_bf16_f32 v97, v97, v97
    v_and_b32 v168, v97, v36
    v_and_b32 v169, v97, v37
    v_and_b32 v170, v97, v38
    v_and_b32 v171, v97, v39
    v_cvt_pk_bf16_f32 v101, v101, v101
    v_and_b32 v172, v101, v36
    v_and_b32 v173, v101, v37
    v_and_b32 v174, v101, v38
    v_and_b32 v175, v101, v39
    v_cvt_pk_bf16_f32 v98, v98, v98
    v_and_b32 v176, v98, v36
    v_and_b32 v177, v98, v37
    v_and_b32 v178, v98, v38
    v_and_b32 v179, v98, v39
    v_cvt_pk_bf16_f32 v102, v102, v102
    v_and_b32 v180, v102, v36
    v_and_b32 v181, v102, v37
    v_and_b32 v182, v102, v38
    v_and_b32 v183, v102, v39
    v_cvt_pk_bf16_f32 v99, v99, v99
    v_and_b32 v184, v99, v36
    v_and_b32 v185, v99, v37
    v_and_b32 v186, v99, v38
    v_and_b32 v187, v99, v39
    v_cvt_pk_bf16_f32 v103, v103, v103
    v_and_b32 v188, v103, v36
    v_and_b32 v189, v103, v37
    v_and_b32 v190, v103, v38
    v_and_b32 v191, v103, v39
    v_cvt_pk_bf16_f32 v104, v104, v104
    v_and_b32 v192, v104, v36
    v_and_b32 v193, v104, v37
    v_and_b32 v194, v104, v38
    v_and_b32 v195, v104, v39
    v_cvt_pk_bf16_f32 v108, v108, v108
    v_and_b32 v196, v108, v36
    v_and_b32 v197, v108, v37
    v_and_b32 v198, v108, v38
    v_and_b32 v199, v108, v39
    v_cvt_pk_bf16_f32 v105, v105, v105
    v_and_b32 v200, v105, v36
    v_and_b32 v201, v105, v37
    v_and_b32 v202, v105, v38
    v_and_b32 v203, v105, v39
    v_cvt_pk_bf16_f32 v109, v109, v109
    v_and_b32 v204, v109, v36
    v_and_b32 v205, v109, v37
    v_and_b32 v206, v109, v38
    v_and_b32 v207, v109, v39
    v_cvt_pk_bf16_f32 v106, v106, v106
    v_and_b32 v208, v106, v36
    v_and_b32 v209, v106, v37
    v_and_b32 v210, v106, v38
    v_and_b32 v211, v106, v39
    v_cvt_pk_bf16_f32 v110, v110, v110
    v_and_b32 v212, v110, v36
    v_and_b32 v213, v110, v37
    v_and_b32 v214, v110, v38
    v_and_b32 v215, v110, v39
    v_cvt_pk_bf16_f32 v107, v107, v107
    v_and_b32 v216, v107, v36
    v_and_b32 v217, v107, v37
    v_and_b32 v218, v107, v38
    v_and_b32 v219, v107, v39
    v_cvt_pk_bf16_f32 v111, v111, v111
    v_and_b32 v220, v111, v36
    v_and_b32 v221, v111, v37
    v_and_b32 v222, v111, v38
    v_and_b32 v223, v111, v39
    v_cvt_pk_bf16_f32 v112, v112, v112
    v_and_b32 v224, v112, v36
    v_and_b32 v225, v112, v37
    v_and_b32 v226, v112, v38
    v_and_b32 v227, v112, v39
    v_cvt_pk_bf16_f32 v116, v116, v116
    v_and_b32 v228, v116, v36
    v_and_b32 v229, v116, v37
    v_and_b32 v230, v116, v38
    v_and_b32 v231, v116, v39
    v_cvt_pk_bf16_f32 v113, v113, v113
    v_and_b32 v232, v113, v36
    v_and_b32 v233, v113, v37
    v_and_b32 v234, v113, v38
    v_and_b32 v235, v113, v39
    v_cvt_pk_bf16_f32 v117, v117, v117
    v_and_b32 v236, v117, v36
    v_and_b32 v237, v117, v37
    v_and_b32 v238, v117, v38
    v_and_b32 v239, v117, v39
    v_cvt_pk_bf16_f32 v114, v114, v114
    v_and_b32 v64, v114, v36
    v_and_b32 v65, v114, v37
    v_and_b32 v66, v114, v38
    v_and_b32 v67, v114, v39
    v_cvt_pk_bf16_f32 v118, v118, v118
    v_and_b32 v68, v118, v36
    v_and_b32 v69, v118, v37
    v_and_b32 v70, v118, v38
    v_and_b32 v71, v118, v39
    v_cvt_pk_bf16_f32 v115, v115, v115
    v_and_b32 v72, v115, v36
    v_and_b32 v73, v115, v37
    v_and_b32 v74, v115, v38
    v_and_b32 v75, v115, v39
    v_cvt_pk_bf16_f32 v119, v119, v119
    v_and_b32 v76, v119, v36
    v_and_b32 v77, v119, v37
    v_and_b32 v78, v119, v38
    v_and_b32 v79, v119, v39
    v_cvt_pk_bf16_f32 v120, v120, v120
    v_and_b32 v2, v120, v36
    v_and_b32 v3, v120, v37
    v_and_b32 v4, v120, v38
    v_and_b32 v5, v120, v39
    v_cvt_pk_bf16_f32 v124, v124, v124
    v_and_b32 v6, v124, v36
    v_and_b32 v7, v124, v37
    v_and_b32 v8, v124, v38
    v_and_b32 v9, v124, v39
    v_cvt_pk_bf16_f32 v121, v121, v121
    v_and_b32 v10, v121, v36
    v_and_b32 v11, v121, v37
    v_and_b32 v12, v121, v38
    v_and_b32 v13, v121, v39
    v_cvt_pk_bf16_f32 v125, v125, v125
    v_and_b32 v14, v125, v36
    v_and_b32 v15, v125, v37
    v_and_b32 v16, v125, v38
    v_and_b32 v17, v125, v39
    v_cvt_pk_bf16_f32 v122, v122, v122
    v_and_b32 v18, v122, v36
    v_and_b32 v19, v122, v37
    v_and_b32 v20, v122, v38
    v_and_b32 v21, v122, v39
    v_cvt_pk_bf16_f32 v126, v126, v126
    v_and_b32 v22, v126, v36
    v_and_b32 v23, v126, v37
    v_and_b32 v24, v126, v38
    v_and_b32 v25, v126, v39
    v_cvt_pk_bf16_f32 v123, v123, v123
    v_and_b32 v40, v123, v36
    v_and_b32 v41, v123, v37
    v_and_b32 v42, v123, v38
    v_and_b32 v43, v123, v39
    v_cvt_pk_bf16_f32 v127, v127, v127
    v_and_b32 v44, v127, v36
    v_and_b32 v45, v127, v37
    v_and_b32 v46, v127, v38
    v_and_b32 v47, v127, v39
    s_lshl_b32 s40, s38, 10
    v_add_u32 v80, s40, v85
    s_lshl_b32 s40, s38, 2
    v_mov_b32 v82, s40
    s_mov_b32 s42, 131072
    s_mov_b32 s41, 64
L_ld:
    ds_read_b32 v30, v34 offset:43584
    s_sub_u32 s42, s42, 1
    s_cbranch_scc1 L_ldx
    s_waitcnt lgkmcnt(0)
    v_cmp_gt_u32 vcc, s41, v30
    s_cbranch_vccnz L_ld
L_ldx:
    global_load_dwordx4 v[96:99], v48, s[48:49] offset:0 nt
    global_load_dwordx4 v[100:103], v48, s[48:49] offset:1152 nt
    global_load_dwordx4 v[104:107], v48, s[48:49] offset:2304 nt
    global_load_dwordx4 v[108:111], v48, s[48:49] offset:3456 nt
    s_barrier
    v_mov_b32 v31, 0
    s_mov_b32 s42, 131072
L_fs:
    ds_read_b32 v30, v31 offset:44636
    s_sub_u32 s42, s42, 1
    s_cbranch_scc1 L_fsx
    s_waitcnt lgkmcnt(0)
    v_cmp_eq_u32 vcc, 0, v30
    s_cbranch_vccnz L_fs
L_fsx:
    s_waitcnt lgkmcnt(0)
    global_load_dwordx4 v[112:115], v49, s[48:49] offset:0 nt
    global_load_dwordx4 v[116:119], v49, s[48:49] offset:1152 nt
    global_load_dwordx4 v[120:123], v49, s[48:49] offset:2304 nt
    global_load_dwordx4 v[124:127], v49, s[48:49] offset:3456 nt
    global_load_dwordx4 v[128:131], v50, s[48:49] offset:0 nt
    global_load_dwordx4 v[132:135], v50, s[48:49] offset:1152 nt
    global_load_dwordx4 v[136:139], v50, s[48:49] offset:2304 nt
    global_load_dwordx4 v[140:143], v50, s[48:49] offset:3456 nt
    global_load_dwordx4 v[144:147], v51, s[48:49] offset:0 nt
    global_load_dwordx4 v[148:151], v51, s[48:49] offset:1152 nt
    global_load_dwordx4 v[152:155], v51, s[48:49] offset:2304 nt
    global_load_dwordx4 v[156:159], v51, s[48:49] offset:3456 nt
    s_waitcnt vmcnt(15)
    v_mfma_f32_16x16x32_bf16 v[56:59], v[160:163], v[96:99], 0
    v_mfma_f32_16x16x32_bf16 v[60:63], v[164:167], v[96:99], 0
    s_waitcnt vmcnt(14)
    v_mfma_f32_16x16x32_bf16 v[56:59], v[168:171], v[100:103], v[56:59]
    v_mfma_f32_16x16x32_bf16 v[60:63], v[172:175], v[100:103], v[60:63]
    s_waitcnt vmcnt(13)
    v_mfma_f32_16x16x32_bf16 v[56:59], v[176:179], v[104:107], v[56:59]
    v_mfma_f32_16x16x32_bf16 v[60:63], v[180:183], v[104:107], v[60:63]
    s_waitcnt vmcnt(12)
    v_mfma_f32_16x16x32_bf16 v[56:59], v[184:187], v[108:111], v[56:59]
    v_mfma_f32_16x16x32_bf16 v[60:63], v[188:191], v[108:111], v[60:63]
    s_waitcnt vmcnt(11)
    v_mfma_f32_16x16x32_bf16 v[56:59], v[192:195], v[112:115], v[56:59]
    v_mfma_f32_16x16x32_bf16 v[60:63], v[196:199], v[112:115], v[60:63]
    s_waitcnt vmcnt(10)
    v_mfma_f32_16x16x32_bf16 v[56:59], v[200:203], v[116:119], v[56:59]
    v_mfma_f32_16x16x32_bf16 v[60:63], v[204:207], v[116:119], v[60:63]
    s_waitcnt vmcnt(9)
    v_mfma_f32_16x16x32_bf16 v[56:59], v[208:211], v[120:123], v[56:59]
    v_mfma_f32_16x16x32_bf16 v[60:63], v[212:215], v[120:123], v[60:63]
    s_waitcnt vmcnt(8)
    v_mfma_f32_16x16x32_bf16 v[56:59], v[216:219], v[124:127], v[56:59]
    v_mfma_f32_16x16x32_bf16 v[60:63], v[220:223], v[124:127], v[60:63]
    s_waitcnt vmcnt(7)
    v_mfma_f32_16x16x32_bf16 v[56:59], v[224:227], v[128:131], v[56:59]
    v_mfma_f32_16x16x32_bf16 v[60:63], v[228:231], v[128:131], v[60:63]
    s_waitcnt vmcnt(6)
    v_mfma_f32_16x16x32_bf16 v[56:59], v[232:235], v[132:135], v[56:59]
    v_mfma_f32_16x16x32_bf16 v[60:63], v[236:239], v[132:135], v[60:63]
    s_waitcnt vmcnt(5)
    v_mfma_f32_16x16x32_bf16 v[56:59], v[64:67], v[136:139], v[56:59]
    v_mfma_f32_16x16x32_bf16 v[60:63], v[68:71], v[136:139], v[60:63]
    s_waitcnt vmcnt(4)
    v_mfma_f32_16x16x32_bf16 v[56:59], v[72:75], v[140:143], v[56:59]
    v_mfma_f32_16x16x32_bf16 v[60:63], v[76:79], v[140:143], v[60:63]
    s_waitcnt vmcnt(3)
    v_mfma_f32_16x16x32_bf16 v[56:59], v[2:5], v[144:147], v[56:59]
    v_mfma_f32_16x16x32_bf16 v[60:63], v[6:9], v[144:147], v[60:63]
    s_waitcnt vmcnt(2)
    v_mfma_f32_16x16x32_bf16 v[56:59], v[10:13], v[148:151], v[56:59]
    v_mfma_f32_16x16x32_bf16 v[60:63], v[14:17], v[148:151], v[60:63]
    s_waitcnt vmcnt(1)
    v_mfma_f32_16x16x32_bf16 v[56:59], v[18:21], v[152:155], v[56:59]
    v_mfma_f32_16x16x32_bf16 v[60:63], v[22:25], v[152:155], v[60:63]
    s_waitcnt vmcnt(0)
    v_mfma_f32_16x16x32_bf16 v[56:59], v[40:43], v[156:159], v[56:59]
    v_mfma_f32_16x16x32_bf16 v[60:63], v[44:47], v[156:159], v[60:63]
    s_nop 7
    v_add_f32_dpp v252, v60, v56 row_ror:8 row_mask:0xf bank_mask:0xf
    v_add_f32_dpp v253, v61, v57 row_ror:8 row_mask:0xf bank_mask:0xf
    v_add_f32_dpp v254, v62, v58 row_ror:8 row_mask:0xf bank_mask:0xf
    v_add_f32_dpp v255, v63, v59 row_ror:8 row_mask:0xf bank_mask:0xf
    s_cmp_eq_u32 s38, 3
    s_cbranch_scc1 L_d3
    ds_write_b128 v80, v[252:255] offset:0
    ds_write_b32 v82, v84 offset:44644
    s_waitcnt lgkmcnt(0)
    s_branch L_done
L_d3:
    v_mov_b32 v31, 0
    s_mov_b32 s42, 131072
L_fd:
    ds_read_b64 v[32:33], v31 offset:44648
    ds_read_b128 v[48:51], v85 offset:1024
    ds_read_b128 v[52:55], v85 offset:2048
    s_sub_u32 s42, s42, 1
    s_cbranch_scc1 L_fdx
    s_waitcnt lgkmcnt(0)
    v_min_u32 v30, v32, v33
    v_cmp_eq_u32 vcc, 0, v30
    s_cbranch_vccnz L_fd
L_fdx:
    s_waitcnt lgkmcnt(0)
    v_pk_add_f32 v[252:253], v[252:253], v[48:49]
    v_pk_add_f32 v[254:255], v[254:255], v[50:51]
    v_pk_add_f32 v[252:253], v[252:253], v[52:53]
    v_pk_add_f32 v[254:255], v[254:255], v[54:55]
    v_bfi_b32 v252, v84, s76, v252
    v_bfi_b32 v253, v84, s77, v253
    v_bfi_b32 v254, v84, s78, v254
    v_bfi_b32 v255, v84, s79, v255
    s_mov_b32 exec_lo, 0xff00ff
    s_mov_b32 exec_hi, 0xff00ff00
    global_store_dwordx4 v248, v[252:255], s[30:31] sc1
    ds_write_b32 v34, v84 offset:44628
    s_waitcnt lgkmcnt(0)
    s_branch L_done
    s_endpgm
.section .rodata,"a"
.p2align 6
.amdhsa_kernel recurrent_scan__gqa_block_cached__glu_gated_reglu__decode_kernel
  .amdhsa_next_free_vgpr 256
  .amdhsa_next_free_sgpr 102
  .amdhsa_accum_offset 256
  .amdhsa_group_segment_fixed_size 0
  .amdhsa_kernarg_size 96
  .amdhsa_user_sgpr_count 2
  .amdhsa_user_sgpr_kernarg_segment_ptr 1
  .amdhsa_system_sgpr_workgroup_id_x 1
  .amdhsa_float_denorm_mode_32 3
.end_amdhsa_kernel
```
